```python
import torch

def _softmax(x, axis=-1):
    return torch.softmax(x, dim=axis)

def _gelu(x):
    return torch.nn.functional.gelu(x, approximate='tanh')

def _silu(x):
    return torch.nn.functional.silu(x)

def _sigmoid(x):
    return torch.sigmoid(x)

def _layernorm(x, axis=-1, eps=1e-05):
    m = x.mean(dim=axis, keepdim=True)
    v = x.var(dim=axis, keepdim=True, unbiased=False)
    return (x - m) / torch.sqrt(v + eps)

def _scatter_add(tgt, idx, src, axis=0):
    return tgt.clone().index_add_(axis, idx, src)

def _segment_sum(src, seg, n):
    out = torch.zeros((n,) + src.shape[1:], dtype=src.dtype)
    return out.index_add_(0, seg, src)

def _pad(x, pw):
    flat = tuple((v for pair in reversed(pw) for v in pair))
    return torch.nn.functional.pad(x, flat)
kernel_name = 'adaLN_cond__ssm_conv_s4__mixer_s_mlp__prompt'

def setup_inputs():

    _w = lambda a: (lambda t: t.to(torch.bfloat16) if t.is_floating_point() else t)(torch.as_tensor(a))

    def _A_setup():
        B, L, D, N = (1, 2048, 512, 128)
        A_re = -(lambda _x: torch.exp(torch.as_tensor(_x)))((lambda *s: torch.randn(*s, dtype=torch.bfloat16) * 3.2)(D, N))
        A_im = torch.pi * (lambda *s: torch.randn(*s, dtype=torch.bfloat16) * 0.1)(D, N)
        B_re = (lambda *s: torch.randn(*s, dtype=torch.bfloat16) * 0.2)(D, N)
        B_im = (lambda *s: torch.randn(*s, dtype=torch.bfloat16) * 0.2)(D, N)
        C_re = (lambda *s: torch.randn(*s, dtype=torch.bfloat16) * 0.2)(D, N)
        C_im = (lambda *s: torch.randn(*s, dtype=torch.bfloat16) * 0.2)(D, N)
        log_dt = (lambda *s: torch.randn(*s, dtype=torch.bfloat16) * 0.1)(D) * 0.5 - 4.0
        Dskip = (lambda *s: torch.randn(*s, dtype=torch.bfloat16) * 0.1)(D)
        return {'u': _w((lambda *s: torch.randn(*s, dtype=torch.bfloat16) * 0.05)(B, L, D)), 'A_re': _w(A_re), 'A_im': _w(A_im), 'B_re': _w(B_re), 'B_im': _w(B_im), 'C_re': _w(C_re), 'C_im': _w(C_im), 'log_dt': _w(log_dt), 'Dskip': _w(Dskip)}
    _A_in = _A_setup()

    def _B_setup():
        B, S, D, F = (1, 2048, 512, 1376)
        return {'x': _w((lambda *s: torch.randn(*s, dtype=torch.bfloat16) * 0.05)(B, S, D)), 'w1': _w((lambda *s: torch.randn(*s, dtype=torch.bfloat16) * 3.2)(D, D) * D ** (-0.5)), 'w2': _w((lambda *s: torch.randn(*s, dtype=torch.bfloat16) * 3.2)(D, D) * D ** (-0.5)), 'w3': _w((lambda *s: torch.randn(*s, dtype=torch.bfloat16) * 3.2)(D, F) * D ** (-0.5)), 'w4': _w((lambda *s: torch.randn(*s, dtype=torch.bfloat16) * 1.6)(F, D) * F ** (-0.5))}
    _B_in = _B_setup()
    return {'A_u': _A_in['u'], 'A_A_re': _A_in['A_re'], 'A_A_im': _A_in['A_im'], 'A_B_re': _A_in['B_re'], 'A_B_im': _A_in['B_im'], 'A_C_re': _A_in['C_re'], 'A_C_im': _A_in['C_im'], 'A_log_dt': _A_in['log_dt'], 'A_Dskip': _A_in['Dskip'], 'B_x': _B_in['x'], 'B_w1': _B_in['w1'], 'B_w2': _B_in['w2'], 'B_w3': _B_in['w3'], 'B_w4': _B_in['w4'], 'c': _w((lambda *s: torch.randn(*s, dtype=torch.bfloat16) * 0.1)(1, 512) * 8.0), 'w_mod': _w((lambda *s: torch.randn(*s, dtype=torch.bfloat16) * 0.1)(512, 6 * 512) * 512 ** (-0.5) * 8.0)}

def reference(A_u, A_A_re, A_A_im, A_B_re, A_B_im, A_C_re, A_C_im, A_log_dt, A_Dskip, B_x, B_w1, B_w2, B_w3, B_w4, c, w_mod):

    def _A_ref(u, A_re, A_im, B_re, B_im, C_re, C_im, log_dt, Dskip):
        Bsz, L, D = u.shape
        dt = torch.exp(log_dt)[:, None]
        A = A_re + 1j * A_im
        Bc = B_re + 1j * B_im
        Cc = C_re + 1j * C_im
        logdA = dt * A
        dB = dt * Bc
        l = (lambda x, dt: x.to(dt))(torch.arange(L), A_re.dtype)
        P = torch.exp(logdA[:, :, None] * l[None, None, :])
        K = torch.einsum('dn,dnl,dn->dl', Cc, P, dB).real
        L2 = 2 * L
        Kp = _pad(K, ((0, 0), (0, L)))
        up = (lambda x, *d: x.permute(*d))(u, 0, 2, 1)
        up = _pad(up, ((0, 0), (0, 0), (0, L)))
        Kf = (lambda x, axes=(-2, -1): torch.fft.rfft2(x.float(), dim=axes))(Kp[:, None, :], axes=(-2, -1))
        Uf = (lambda x, axes=(-2, -1): torch.fft.rfft2(x.float(), dim=axes))(up[:, :, None, :], axes=(-2, -1))
        Yf = Uf * Kf[None, :, :, :]
        y = (lambda x, s, axes=(-2, -1): torch.fft.irfft2(x, s=s, dim=axes).to(torch.bfloat16))(Yf, (1, L2), axes=(-2, -1))[:, :, 0, :L]
        y = (lambda x, *d: x.permute(*d))(y, 0, 2, 1) + u * Dskip[None, None, :]
        return y

    def _B_ref(x, w1, w2, w3, w4):
        B, S, D = x.shape
        h = _gelu(_layernorm(x, axis=-1) @ w1)
        c = D // 4
        g0 = _pad(h[:, :, 0 * c:1 * c], ((0, 0), (1, 0), (0, 0)))[:, :S, :]
        g1 = _pad(h[:, :, 1 * c:2 * c], ((0, 0), (0, 1), (0, 0)))[:, 1:, :]
        g2 = _pad(h[:, :, 2 * c:3 * c], ((0, 0), (2, 0), (0, 0)))[:, :S, :]
        g3 = _pad(h[:, :, 3 * c:], ((0, 0), (0, 2), (0, 0)))[:, 2:, :]
        hs = torch.concatenate([g0, g1, g2, g3], axis=-1) @ w2
        x1 = x + hs
        h2 = _gelu(_layernorm(x1, axis=-1) @ w3) @ w4
        return x1 + h2
    x = A_u
    mod = (_silu(c) @ w_mod).reshape(c.shape[0], 6, 1, -1)
    sa, ca, ga, sb, cb, gb = (mod[:, 0].clone(), mod[:, 1].clone(), mod[:, 2].clone(), mod[:, 3].clone(), mod[:, 4].clone(), mod[:, 5].clone())
    h = _layernorm(x, axis=-1) * (1 + ca) + sa
    x = x + ga * _A_ref(h, A_A_re, A_A_im, A_B_re, A_B_im, A_C_re, A_C_im, A_log_dt, A_Dskip)
    h = _layernorm(x, axis=-1) * (1 + cb) + sb
    x = x + gb * _B_ref(h, B_w1, B_w2, B_w3, B_w4)
    return x
```

```asm
; @launch kernel=adaLN_cond__ssm_conv_s4__mixer_s_mlp__prompt_kernel grid=(512,1,1) block=(256,1,1) lds=67584
; @launch kernel=mlp_kernel grid=(256,1,1) block=(256,1,1) lds=70656
.amdgcn_target "amdgcn-amd-amdhsa--gfx950"
.text
.p2align 8
CODE_BEGIN:
.globl adaLN_cond__ssm_conv_s4__mixer_s_mlp__prompt_kernel
.p2align 8
.type adaLN_cond__ssm_conv_s4__mixer_s_mlp__prompt_kernel,@function
adaLN_cond__ssm_conv_s4__mixer_s_mlp__prompt_kernel:
    s_cmp_ge_u32 s2, 512
    s_cbranch_scc1 .LadaLN__end_7
    s_load_dwordx16 s[4:19], s[0:1], 0
    s_load_dwordx16 s[20:35], s[0:1], 64
    s_load_dwordx4 s[36:39], s[0:1], 128
    s_load_dwordx2 s[40:41], s[0:1], 144
    s_cmp_lt_u32 s2, 8
    s_cbranch_scc0 .LadaLN__pre0_8
    s_getpc_b64 s[44:45]
.LadaLN__pc0_9:
    s_sub_u32 s44, s44, .LadaLN__pc0_9-CODE_BEGIN
    s_subb_u32 s45, s45, 0
    v_lshrrev_b32 v100, 6, v0
    v_lshlrev_b32 v100, 13, v100
    v_and_b32 v101, 63, v0
    v_lshl_add_u32 v100, v101, 7, v100
    v_min_u32 v100, CODE_FROM-CODE_BEGIN-4, v100
    global_load_dword v101, v100, s[44:45]
.LadaLN__pre0_8:
    v_lshrrev_b32 v1, 6, v0
    s_nop 0
    v_readfirstlane_b32 s42, v1
    s_waitcnt lgkmcnt(0)
    s_cmp_lt_u32 s2, 256
    s_cbranch_scc1 .LadaLN__K_4
    s_cmp_eq_u32 s42, 0
    s_cbranch_scc0 .LadaLN__pre_10
    s_cmp_ge_u32 s2, 480
    s_cbranch_scc0 .LadaLN__pre_10
    v_and_b32 v100, 63, v0
    s_getpc_b64 s[44:45]
.LadaLN__pc_11:
    s_add_u32 s44, s44, CODE_FROM-.LadaLN__pc_11
    s_addc_u32 s45, s45, 0
    s_sub_u32 s46, s2, 480
    s_lshr_b32 s46, s46, 3
    s_cmp_lt_u32 s46, (CODE_TO-CODE_FROM+8191)/8192
    s_cbranch_scc0 .LadaLN__pre_10
    s_lshl_b32 s46, s46, 13
    v_lshlrev_b32 v101, 7, v100
    v_add_u32 v101, s46, v101
    v_min_u32 v101, CODE_TO-CODE_FROM-4, v101
    global_load_dword v104, v101, s[44:45]
.LadaLN__pre_10:
    s_cmp_ge_u32 s2, 476
    s_cbranch_scc1 .LadaLN__end_7
    s_cmp_ge_u32 s2, 460
    s_cbranch_scc1 .LadaLN__Z_5
    s_cmp_eq_u32 s2, 456
    s_cbranch_scc1 .LadaLN__N_6
    s_cmp_ge_u32 s2, 456
    s_cbranch_scc1 .LadaLN__end_7
    s_cmp_ge_u32 s2, 384
    s_cbranch_scc1 .LadaLN__M_2
.LadaLN__X_1:
    s_setprio 3
    s_mov_b32 s48, s4
    s_mov_b32 s49, s5
    s_mov_b32 s50, 0x200000
    s_mov_b32 s51, 0x20000
    s_add_u32 s52, s40, 0x1e00000
    s_addc_u32 s53, s41, 0
    s_mov_b32 s54, 0x204000
    s_mov_b32 s55, 0x20000
    s_add_u32 s56, s40, 0x2100000
    s_addc_u32 s57, s41, 0
    s_mov_b32 s58, 0x204000
    s_mov_b32 s59, 0x20000
    s_sub_u32 s43, s2, 256
    s_lshl_b32 s46, s43, 4
    v_and_b32 v2, 63, v0
    v_lshrrev_b32 v4, 4, v2
    s_lshl_b32 s44, s42, 2
    v_add_u32 v5, s44, v4
    v_add_u32 v4, s46, v5
    v_lshlrev_b32 v3, 10, v4
    v_and_b32 v4, 15, v2
    v_lshl_add_u32 v3, v4, 4, v3
    buffer_load_dwordx4 v[8:11], v3, s[48:51], 0 offen offset:0
    buffer_load_dwordx4 v[12:15], v3, s[48:51], 0 offen offset:256
    buffer_load_dwordx4 v[16:19], v3, s[48:51], 0 offen offset:512
    buffer_load_dwordx4 v[20:23], v3, s[48:51], 0 offen offset:768
    v_mul_u32_u24 v6, 1056, v5
    v_lshlrev_b32 v7, 2, v5
    v_and_b32 v5, 8, v5
    v_add_u32 v4, v4, v5
    v_lshl_add_u32 v6, v4, 4, v6
    v_mov_b32 v44, 0x3f803f80
    v_mov_b32 v40, 0
    v_mov_b32 v41, 0
    v_mov_b32 v42, 0
    v_mov_b32 v43, 0
    s_waitcnt vmcnt(3)
    v_dot2_f32_bf16 v40, v8, v44, v40
    v_dot2_f32_bf16 v42, v8, v8, v42
    v_dot2_f32_bf16 v41, v9, v44, v41
    v_dot2_f32_bf16 v43, v9, v9, v43
    v_dot2_f32_bf16 v40, v10, v44, v40
    v_dot2_f32_bf16 v42, v10, v10, v42
    v_dot2_f32_bf16 v41, v11, v44, v41
    v_dot2_f32_bf16 v43, v11, v11, v43
    ds_write_b128 v6, v[8:11] offset:0
    s_waitcnt vmcnt(2)
    v_dot2_f32_bf16 v40, v12, v44, v40
    v_dot2_f32_bf16 v42, v12, v12, v42
    v_dot2_f32_bf16 v41, v13, v44, v41
    v_dot2_f32_bf16 v43, v13, v13, v43
    v_dot2_f32_bf16 v40, v14, v44, v40
    v_dot2_f32_bf16 v42, v14, v14, v42
    v_dot2_f32_bf16 v41, v15, v44, v41
    v_dot2_f32_bf16 v43, v15, v15, v43
    ds_write_b128 v6, v[12:15] offset:256
    s_waitcnt vmcnt(1)
    v_dot2_f32_bf16 v40, v16, v44, v40
    v_dot2_f32_bf16 v42, v16, v16, v42
    v_dot2_f32_bf16 v41, v17, v44, v41
    v_dot2_f32_bf16 v43, v17, v17, v43
    v_dot2_f32_bf16 v40, v18, v44, v40
    v_dot2_f32_bf16 v42, v18, v18, v42
    v_dot2_f32_bf16 v41, v19, v44, v41
    v_dot2_f32_bf16 v43, v19, v19, v43
    ds_write_b128 v6, v[16:19] offset:512
    s_waitcnt vmcnt(0)
    v_dot2_f32_bf16 v40, v20, v44, v40
    v_dot2_f32_bf16 v42, v20, v20, v42
    v_dot2_f32_bf16 v41, v21, v44, v41
    v_dot2_f32_bf16 v43, v21, v21, v43
    v_dot2_f32_bf16 v40, v22, v44, v40
    v_dot2_f32_bf16 v42, v22, v22, v42
    v_dot2_f32_bf16 v41, v23, v44, v41
    v_dot2_f32_bf16 v43, v23, v23, v43
    ds_write_b128 v6, v[20:23] offset:768
    s_mov_b32 s76, s38
    s_mov_b32 s77, s39
    s_mov_b32 s78, 0x100
    s_mov_b32 s79, 0x20000
    v_mov_b32 v4, 0
    buffer_load_dword v110, v4, s[76:79], 0 offen sc1
    v_add_f32 v40, v40, v41
    v_add_f32 v42, v42, v43
    s_nop 0
    v_add_f32_dpp v40, v40, v40 quad_perm:[1,0,3,2] row_mask:0xf bank_mask:0xf
    v_add_f32_dpp v42, v42, v42 quad_perm:[1,0,3,2] row_mask:0xf bank_mask:0xf
    s_nop 0
    v_add_f32_dpp v40, v40, v40 quad_perm:[2,3,0,1] row_mask:0xf bank_mask:0xf
    v_add_f32_dpp v42, v42, v42 quad_perm:[2,3,0,1] row_mask:0xf bank_mask:0xf
    s_nop 0
    v_add_f32_dpp v40, v40, v40 row_half_mirror row_mask:0xf bank_mask:0xf
    v_add_f32_dpp v42, v42, v42 row_half_mirror row_mask:0xf bank_mask:0xf
    s_nop 0
    v_add_f32_dpp v40, v40, v40 row_mirror row_mask:0xf bank_mask:0xf
    v_add_f32_dpp v42, v42, v42 row_mirror row_mask:0xf bank_mask:0xf
    v_mul_f32 v40, 0x3b000000, v40
    v_mul_f32 v41, v40, v40
    v_mov_b32 v43, 0x3b000000
    v_fma_f32 v42, v42, v43, -v41
    v_max_f32 v42, 0, v42
    v_add_f32 v42, 0x3727c5ac, v42
    v_rsq_f32 v42, v42
    s_nop 0
    v_mul_f32 v40, v40, v42
    v_sub_f32 v40, 0, v40
    ds_write_b32 v7, v42 offset:17408
    ds_write_b32 v7, v40 offset:17536
    s_waitcnt lgkmcnt(0)
    s_barrier
    v_bfe_u32 v4, v2, 4, 1
    v_lshlrev_b32 v5, 5, v4
    ds_read_b128 v[48:51], v5 offset:17408
    ds_read_b128 v[52:55], v5 offset:17424
    ds_read_b128 v[56:59], v5 offset:17536
    ds_read_b128 v[60:63], v5 offset:17552
    v_bfe_u32 v5, v2, 2, 2
    v_lshl_add_u32 v5, v4, 3, v5
    v_mul_u32_u24 v6, 1056, v5
    v_lshl_add_u32 v6, v4, 7, v6
    v_and_b32 v5, 3, v2
    v_lshl_add_u32 v6, v5, 3, v6
    v_lshrrev_b32 v5, 5, v2
    v_lshl_add_u32 v6, v5, 5, v6
    s_lshl_b32 s44, s42, 8
    v_add_u32 v6, s44, v6
    v_and_b32 v3, 15, v2
    v_lshl_add_u32 v3, v5, 4, v3
    s_lshl_b32 s44, s42, 7
    v_add_u32 v3, s44, v3
    v_lshlrev_b32 v3, 5, v3
    v_lshl_add_u32 v3, v4, 4, v3
    s_mul_i32 s45, s43, 16512
    ds_read_b64_tr_b16 v[8:9], v6 offset:0
    ds_read_b64_tr_b16 v[10:11], v6 offset:4224
    ds_read_b64_tr_b16 v[12:13], v6 offset:64
    ds_read_b64_tr_b16 v[14:15], v6 offset:4288
    ds_read_b64_tr_b16 v[16:17], v6 offset:128
    ds_read_b64_tr_b16 v[18:19], v6 offset:4352
    ds_read_b64_tr_b16 v[20:21], v6 offset:192
    ds_read_b64_tr_b16 v[22:23], v6 offset:4416
    s_waitcnt lgkmcnt(8)
    s_waitcnt lgkmcnt(6)
    v_lshlrev_b32 v64, 16, v8
    v_and_b32 v65, 0xffff0000, v8
    v_lshlrev_b32 v66, 16, v9
    v_and_b32 v67, 0xffff0000, v9
    v_lshlrev_b32 v68, 16, v10
    v_and_b32 v69, 0xffff0000, v10
    v_lshlrev_b32 v70, 16, v11
    v_and_b32 v71, 0xffff0000, v11
    v_pk_fma_f32 v[64:65], v[64:65], v[48:49], v[56:57]
    v_pk_fma_f32 v[66:67], v[66:67], v[50:51], v[58:59]
    v_pk_fma_f32 v[68:69], v[68:69], v[52:53], v[60:61]
    v_pk_fma_f32 v[70:71], v[70:71], v[54:55], v[62:63]
    v_cvt_pk_bf16_f32 v72, v64, v65
    v_cvt_pk_bf16_f32 v73, v66, v67
    v_cvt_pk_bf16_f32 v74, v68, v69
    v_cvt_pk_bf16_f32 v75, v70, v71
    buffer_store_dwordx4 v[72:75], v3, s[56:59], s45 offen sc1
    buffer_store_dwordx4 v[8:11], v3, s[52:55], s45 offen sc1
    s_add_u32 s45, s45, 1024
    s_waitcnt lgkmcnt(4)
    v_lshlrev_b32 v64, 16, v12
    v_and_b32 v65, 0xffff0000, v12
    v_lshlrev_b32 v66, 16, v13
    v_and_b32 v67, 0xffff0000, v13
    v_lshlrev_b32 v68, 16, v14
    v_and_b32 v69, 0xffff0000, v14
    v_lshlrev_b32 v70, 16, v15
    v_and_b32 v71, 0xffff0000, v15
    v_pk_fma_f32 v[64:65], v[64:65], v[48:49], v[56:57]
    v_pk_fma_f32 v[66:67], v[66:67], v[50:51], v[58:59]
    v_pk_fma_f32 v[68:69], v[68:69], v[52:53], v[60:61]
    v_pk_fma_f32 v[70:71], v[70:71], v[54:55], v[62:63]
    v_cvt_pk_bf16_f32 v76, v64, v65
    v_cvt_pk_bf16_f32 v77, v66, v67
    v_cvt_pk_bf16_f32 v78, v68, v69
    v_cvt_pk_bf16_f32 v79, v70, v71
    buffer_store_dwordx4 v[76:79], v3, s[56:59], s45 offen sc1
    buffer_store_dwordx4 v[12:15], v3, s[52:55], s45 offen sc1
    s_add_u32 s45, s45, 1024
    s_waitcnt lgkmcnt(2)
    v_lshlrev_b32 v64, 16, v16
    v_and_b32 v65, 0xffff0000, v16
    v_lshlrev_b32 v66, 16, v17
    v_and_b32 v67, 0xffff0000, v17
    v_lshlrev_b32 v68, 16, v18
    v_and_b32 v69, 0xffff0000, v18
    v_lshlrev_b32 v70, 16, v19
    v_and_b32 v71, 0xffff0000, v19
    v_pk_fma_f32 v[64:65], v[64:65], v[48:49], v[56:57]
    v_pk_fma_f32 v[66:67], v[66:67], v[50:51], v[58:59]
    v_pk_fma_f32 v[68:69], v[68:69], v[52:53], v[60:61]
    v_pk_fma_f32 v[70:71], v[70:71], v[54:55], v[62:63]
    v_cvt_pk_bf16_f32 v72, v64, v65
    v_cvt_pk_bf16_f32 v73, v66, v67
    v_cvt_pk_bf16_f32 v74, v68, v69
    v_cvt_pk_bf16_f32 v75, v70, v71
    buffer_store_dwordx4 v[72:75], v3, s[56:59], s45 offen sc1
    buffer_store_dwordx4 v[16:19], v3, s[52:55], s45 offen sc1
    s_add_u32 s45, s45, 1024
    s_waitcnt lgkmcnt(0)
    v_lshlrev_b32 v64, 16, v20
    v_and_b32 v65, 0xffff0000, v20
    v_lshlrev_b32 v66, 16, v21
    v_and_b32 v67, 0xffff0000, v21
    v_lshlrev_b32 v68, 16, v22
    v_and_b32 v69, 0xffff0000, v22
    v_lshlrev_b32 v70, 16, v23
    v_and_b32 v71, 0xffff0000, v23
    v_pk_fma_f32 v[64:65], v[64:65], v[48:49], v[56:57]
    v_pk_fma_f32 v[66:67], v[66:67], v[50:51], v[58:59]
    v_pk_fma_f32 v[68:69], v[68:69], v[52:53], v[60:61]
    v_pk_fma_f32 v[70:71], v[70:71], v[54:55], v[62:63]
    v_cvt_pk_bf16_f32 v76, v64, v65
    v_cvt_pk_bf16_f32 v77, v66, v67
    v_cvt_pk_bf16_f32 v78, v68, v69
    v_cvt_pk_bf16_f32 v79, v70, v71
    buffer_store_dwordx4 v[76:79], v3, s[56:59], s45 offen sc1
    buffer_store_dwordx4 v[20:23], v3, s[52:55], s45 offen sc1
    s_add_u32 s45, s45, 1024
    s_waitcnt vmcnt(0)
    s_barrier
    s_cmp_eq_u32 s42, 0
    s_cbranch_scc0 .LadaLN__pj_12
    v_readfirstlane_b32 s3, v110
    s_nop 0
    s_cmp_lg_u32 s3, 0
    s_cbranch_scc1 .LadaLN__no_14
    s_mov_b32 s76, s38
    s_mov_b32 s77, s39
    s_mov_b32 s78, 0x100
    s_mov_b32 s79, 0x20000
    v_mov_b32 v102, 0
    s_mov_b32 s44, 0
.LadaLN__nl_13:
    buffer_load_dword v110, v102, s[76:79], 0 offen sc1
    s_waitcnt vmcnt(0)
    v_readfirstlane_b32 s3, v110
    s_add_u32 s44, s44, 1
    s_cmp_ge_u32 s44, 0x40000
    s_cbranch_scc1 .LadaLN__no_14
    s_cmp_eq_u32 s3, 0
    s_cbranch_scc1 .LadaLN__nl_13
.LadaLN__no_14:
    s_add_u32 s76, s40, 0x1d10000
    s_addc_u32 s77, s41, 0
    s_mov_b32 s78, 0x4000
    s_mov_b32 s79, 0x20000
    s_lshl_b32 s44, s43, 6
    v_mov_b32 v102, s3
    v_and_b32 v103, 63, v0
    v_cmp_eq_u32 vcc, 0, v103
    v_mov_b32 v103, 0x7ff00000
    s_nop 0
    v_cndmask_b32 v103, v103, 0, vcc
    buffer_store_dword v102, v103, s[76:79], s44 offen sc1
.LadaLN__pj_12:
    s_setprio 0
    s_cmp_lt_u32 s43, 124
    s_cbranch_scc1 .LadaLN__W_3
    s_endpgm
.LadaLN__W_3:
    s_sub_u32 s43, s2, 256
    s_cmp_ge_u32 s43, 76
    s_cbranch_scc1 .LadaLN__w4_19
    s_cmp_ge_u32 s43, 32
    s_cbranch_scc1 .LadaLN__w3_18
    s_cmp_ge_u32 s43, 16
    s_cbranch_scc1 .LadaLN__w2_17
.LadaLN__w1_16:
    s_mov_b32 s48, s24
    s_mov_b32 s49, s25
    s_mov_b32 s50, 0x80000
    s_mov_b32 s51, 0x20000
    s_add_u32 s52, s40, 0x1700000
    s_addc_u32 s53, s41, 0
    s_mov_b32 s54, 0x80000
    s_mov_b32 s55, 0x20000
    s_add_u32 s56, s40, 0x1c04000
    s_addc_u32 s57, s41, 0
    s_mov_b32 s58, 0x1000
    s_mov_b32 s59, 0x20000
    s_lshr_b32 s60, s43, 1
    s_and_b32 s61, s43, 1
    s_mov_b32 s44, 1024
    s_lshr_b32 s46, s42, 1
    s_lshl_b32 s66, s46, 2
    s_and_b32 s67, s42, 1
    s_lshl_b32 s67, s67, 3
    s_mov_b32 s62, 0
    s_lshl_b32 s64, s60, 1
    s_add_u32 s64, s64, s46
    s_lshl_b32 s64, s64, 15
    s_lshl_b32 s47, s61, 14
    s_add_u32 s64, s64, s47
    s_lshl_b32 s47, s67, 7
    s_add_u32 s64, s64, s47
    s_mov_b32 s65, 2048
    s_mov_b32 s68, 8
    s_mov_b32 s63, 1
    s_lshl_b32 s69, s61, 11
    s_lshl_b32 s47, s60, 8
    s_add_u32 s69, s69, s47
    s_lshl_b32 s47, s46, 7
    s_add_u32 s69, s69, s47
    s_lshl_b32 s47, s67, 1
    s_add_u32 s69, s69, s47
    s_branch .LadaLN__wgo_20
.LadaLN__w2_17:
    s_sub_u32 s43, s43, 16
    s_mov_b32 s48, s26
    s_mov_b32 s49, s27
    s_mov_b32 s50, 0x80000
    s_mov_b32 s51, 0x20000
    s_add_u32 s52, s40, 0x1780000
    s_addc_u32 s53, s41, 0
    s_mov_b32 s54, 0x80000
    s_mov_b32 s55, 0x20000
    s_add_u32 s56, s40, 0x1c04000
    s_addc_u32 s57, s41, 0
    s_mov_b32 s58, 0x1000
    s_mov_b32 s59, 0x20000
    s_lshr_b32 s60, s43, 1
    s_and_b32 s61, s43, 1
    s_mov_b32 s44, 1024
    s_lshr_b32 s46, s42, 1
    s_lshl_b32 s66, s46, 2
    s_and_b32 s67, s42, 1
    s_lshl_b32 s67, s67, 3
    s_mov_b32 s62, 0
    s_lshl_b32 s64, s60, 1
    s_add_u32 s64, s64, s46
    s_lshl_b32 s64, s64, 15
    s_lshl_b32 s47, s61, 14
    s_add_u32 s64, s64, s47
    s_lshl_b32 s47, s67, 7
    s_add_u32 s64, s64, s47
    s_mov_b32 s65, 2048
    s_mov_b32 s68, 8
    s_mov_b32 s63, 0
    s_lshl_b32 s69, s61, 11
    s_lshl_b32 s47, s60, 8
    s_add_u32 s69, s69, s47
    s_lshl_b32 s47, s46, 7
    s_add_u32 s69, s69, s47
    s_lshl_b32 s47, s67, 1
    s_add_u32 s69, s69, s47
    s_branch .LadaLN__wgo_20
.LadaLN__w3_18:
    s_sub_u32 s43, s43, 32
    s_mov_b32 s48, s28
    s_mov_b32 s49, s29
    s_mov_b32 s50, 0x158000
    s_mov_b32 s51, 0x20000
    s_add_u32 s52, s40, 0x1800000
    s_addc_u32 s53, s41, 0
    s_mov_b32 s54, 0x158000
    s_mov_b32 s55, 0x20000
    s_add_u32 s56, s40, 0x1c08000
    s_addc_u32 s57, s41, 0
    s_mov_b32 s58, 0x2c00
    s_mov_b32 s59, 0x20000
    s_lshr_b32 s60, s43, 1
    s_and_b32 s61, s43, 1
    s_mov_b32 s44, 2752
    s_lshl_b32 s66, s42, 1
    s_mov_b32 s67, 0
    s_mov_b32 s62, 1
    s_lshl_b32 s64, s60, 2
    s_add_u32 s64, s64, s42
    s_lshl_b32 s46, s64, 6
    s_lshl_b32 s64, s64, 14
    s_lshl_b32 s47, s61, 13
    s_add_u32 s64, s64, s47
    s_mov_b32 s65, 1024
    s_mov_b32 s68, 8
    s_mov_b32 s63, 2
    s_mul_i32 s69, s61, 5632
    s_add_u32 s69, s69, s46
    s_branch .LadaLN__wgo_20
.LadaLN__w4_19:
    s_sub_u32 s43, s43, 76
    s_mov_b32 s48, s30
    s_mov_b32 s49, s31
    s_mov_b32 s50, 0x158000
    s_mov_b32 s51, 0x20000
    s_add_u32 s52, s40, 0x1a00000
    s_addc_u32 s53, s41, 0
    s_mov_b32 s54, 0x158000
    s_mov_b32 s55, 0x20000
    s_add_u32 s56, s40, 0x1c04000
    s_addc_u32 s57, s41, 0
    s_mov_b32 s58, 0x1000
    s_mov_b32 s59, 0x20000
    s_mul_i32 s60, s43, 43
    s_lshr_b32 s60, s60, 8
    s_mul_i32 s46, s60, 6
    s_sub_u32 s61, s43, s46
    s_mov_b32 s44, 1024
    s_lshr_b32 s46, s42, 1
    s_lshl_b32 s66, s46, 2
    s_and_b32 s67, s42, 1
    s_lshl_b32 s67, s67, 3
    s_mov_b32 s62, 0
    s_mul_i32 s64, s60, 176128
    s_lshl_b32 s47, s61, 15
    s_add_u32 s64, s64, s47
    s_lshl_b32 s47, s42, 10
    s_add_u32 s64, s64, s47
    s_lshl_b32 s47, s61, 3
    s_sub_u32 s68, 43, s47
    s_mov_b32 s65, 4096
    s_mov_b32 s63, 0
    s_mov_b32 s69, 0
.LadaLN__wgo_20:
    s_lshl_b32 s46, s61, 8
    s_lshl_b32 s47, s42, 6
    s_add_u32 s46, s46, s47
    s_mul_i32 s45, s46, s44
    s_lshl_b32 s47, s60, 7
    s_add_u32 s45, s45, s47
    v_and_b32 v4, 63, v0
    v_lshrrev_b32 v2, 3, v4
    v_and_b32 v3, 2, v2
    v_and_b32 v4, 7, v4
    v_xor_b32 v4, v4, v3
    v_mul_lo_u32 v2, v2, s44
    v_xor_b32 v3, 4, v4
    v_lshl_add_u32 v3, v3, 4, v2
    v_lshl_add_u32 v2, v4, 4, v2
    s_lshl_b32 s46, s42, 13
    s_add_u32 m0, s46, 0
    s_mov_b32 s47, s45
    buffer_load_dwordx4 v2, s[48:51], s47 offen lds
    s_lshl_b32 s46, s42, 13
    s_add_u32 m0, s46, 1024
    s_lshl_b32 s46, s44, 3
    s_add_u32 s47, s47, s46
    buffer_load_dwordx4 v3, s[48:51], s47 offen lds
    s_lshl_b32 s46, s42, 13
    s_add_u32 m0, s46, 2048
    s_lshl_b32 s46, s44, 3
    s_add_u32 s47, s47, s46
    buffer_load_dwordx4 v2, s[48:51], s47 offen lds
    s_lshl_b32 s46, s42, 13
    s_add_u32 m0, s46, 3072
    s_lshl_b32 s46, s44, 3
    s_add_u32 s47, s47, s46
    buffer_load_dwordx4 v3, s[48:51], s47 offen lds
    s_lshl_b32 s46, s42, 13
    s_add_u32 m0, s46, 4096
    s_lshl_b32 s46, s44, 3
    s_add_u32 s47, s47, s46
    buffer_load_dwordx4 v2, s[48:51], s47 offen lds
    s_lshl_b32 s46, s42, 13
    s_add_u32 m0, s46, 5120
    s_lshl_b32 s46, s44, 3
    s_add_u32 s47, s47, s46
    buffer_load_dwordx4 v3, s[48:51], s47 offen lds
    s_lshl_b32 s46, s42, 13
    s_add_u32 m0, s46, 6144
    s_lshl_b32 s46, s44, 3
    s_add_u32 s47, s47, s46
    buffer_load_dwordx4 v2, s[48:51], s47 offen lds
    s_lshl_b32 s46, s42, 13
    s_add_u32 m0, s46, 7168
    s_lshl_b32 s46, s44, 3
    s_add_u32 s47, s47, s46
    buffer_load_dwordx4 v3, s[48:51], s47 offen lds
    s_cmp_eq_u32 s62, 1
    s_cbranch_scc1 .LadaLN__nat_21
    v_and_b32 v4, 63, v0
    v_and_b32 v6, 3, v4
    v_add_u32 v5, s66, v6
    v_mov_b32 v6, s67
    v_lshrrev_b32 v4, 2, v4
    v_and_b32 v7, 6, v4
    v_xor_b32 v5, v5, v7
    v_lshl_add_u32 v6, v5, 4, v6
    v_and_b32 v5, 3, v4
    v_lshrrev_b32 v4, 2, v4
    v_lshl_add_u32 v5, v4, 3, v5
    v_lshl_add_u32 v6, v5, 7, v6
    s_branch .LadaLN__trj_22
.LadaLN__nat_21:
    v_and_b32 v4, 63, v0
    v_and_b32 v6, 3, v4
    v_lshrrev_b32 v5, 1, v6
    v_add_u32 v5, s66, v5
    v_and_b32 v6, 1, v6
    v_lshlrev_b32 v6, 3, v6
    v_lshrrev_b32 v4, 2, v4
    v_and_b32 v7, 6, v4
    v_xor_b32 v5, v5, v7
    v_lshl_add_u32 v6, v5, 4, v6
    v_and_b32 v5, 3, v4
    v_lshrrev_b32 v4, 2, v4
    v_lshl_add_u32 v5, v4, 3, v5
    v_lshl_add_u32 v6, v5, 7, v6
.LadaLN__trj_22:
    v_and_b32 v8, 63, v0
    v_lshlrev_b32 v8, 4, v8
    v_mov_b32 v12, 0x3f803f80
    v_mov_b32 v13, 0x3f803f80
    v_mov_b32 v14, 0x3f803f80
    v_mov_b32 v15, 0x3f803f80
    v_mov_b32 v16, 0
    v_mov_b32 v17, 0
    v_mov_b32 v18, 0
    v_mov_b32 v19, 0
    s_waitcnt vmcnt(0)
    s_barrier
    ds_read_b64_tr_b16 v[20:21], v6 offset:0
    ds_read_b64_tr_b16 v[22:23], v6 offset:512
    ds_read_b64_tr_b16 v[24:25], v6 offset:4096
    ds_read_b64_tr_b16 v[26:27], v6 offset:4608
    ds_read_b64_tr_b16 v[28:29], v6 offset:8192
    ds_read_b64_tr_b16 v[30:31], v6 offset:8704
    ds_read_b64_tr_b16 v[32:33], v6 offset:12288
    ds_read_b64_tr_b16 v[34:35], v6 offset:12800
    ds_read_b64_tr_b16 v[36:37], v6 offset:16384
    ds_read_b64_tr_b16 v[38:39], v6 offset:16896
    ds_read_b64_tr_b16 v[40:41], v6 offset:20480
    ds_read_b64_tr_b16 v[42:43], v6 offset:20992
    ds_read_b64_tr_b16 v[44:45], v6 offset:24576
    ds_read_b64_tr_b16 v[46:47], v6 offset:25088
    ds_read_b64_tr_b16 v[48:49], v6 offset:28672
    ds_read_b64_tr_b16 v[50:51], v6 offset:29184
    s_waitcnt lgkmcnt(14)
    s_cmp_gt_u32 s68, 0
    s_cselect_b32 s46, s64, 0x7ff00000
    buffer_store_dwordx4 v[20:23], v8, s[52:55], s46 offen
    s_add_u32 s64, s64, s65
    v_mfma_f32_16x16x32_bf16 v[16:19], v[20:23], v[12:15], v[16:19]
    s_waitcnt lgkmcnt(12)
    s_cmp_gt_u32 s68, 1
    s_cselect_b32 s46, s64, 0x7ff00000
    buffer_store_dwordx4 v[24:27], v8, s[52:55], s46 offen
    s_add_u32 s64, s64, s65
    v_mfma_f32_16x16x32_bf16 v[16:19], v[24:27], v[12:15], v[16:19]
    s_waitcnt lgkmcnt(10)
    s_cmp_gt_u32 s68, 2
    s_cselect_b32 s46, s64, 0x7ff00000
    buffer_store_dwordx4 v[28:31], v8, s[52:55], s46 offen
    s_add_u32 s64, s64, s65
    v_mfma_f32_16x16x32_bf16 v[16:19], v[28:31], v[12:15], v[16:19]
    s_waitcnt lgkmcnt(8)
    s_cmp_gt_u32 s68, 3
    s_cselect_b32 s46, s64, 0x7ff00000
    buffer_store_dwordx4 v[32:35], v8, s[52:55], s46 offen
    s_add_u32 s64, s64, s65
    v_mfma_f32_16x16x32_bf16 v[16:19], v[32:35], v[12:15], v[16:19]
    s_waitcnt lgkmcnt(6)
    s_cmp_gt_u32 s68, 4
    s_cselect_b32 s46, s64, 0x7ff00000
    buffer_store_dwordx4 v[36:39], v8, s[52:55], s46 offen
    s_add_u32 s64, s64, s65
    v_mfma_f32_16x16x32_bf16 v[16:19], v[36:39], v[12:15], v[16:19]
    s_waitcnt lgkmcnt(4)
    s_cmp_gt_u32 s68, 5
    s_cselect_b32 s46, s64, 0x7ff00000
    buffer_store_dwordx4 v[40:43], v8, s[52:55], s46 offen
    s_add_u32 s64, s64, s65
    v_mfma_f32_16x16x32_bf16 v[16:19], v[40:43], v[12:15], v[16:19]
    s_waitcnt lgkmcnt(2)
    s_cmp_gt_u32 s68, 6
    s_cselect_b32 s46, s64, 0x7ff00000
    buffer_store_dwordx4 v[44:47], v8, s[52:55], s46 offen
    s_add_u32 s64, s64, s65
    v_mfma_f32_16x16x32_bf16 v[16:19], v[44:47], v[12:15], v[16:19]
    s_waitcnt lgkmcnt(0)
    s_cmp_gt_u32 s68, 7
    s_cselect_b32 s46, s64, 0x7ff00000
    buffer_store_dwordx4 v[48:51], v8, s[52:55], s46 offen
    s_add_u32 s64, s64, s65
    v_mfma_f32_16x16x32_bf16 v[16:19], v[48:51], v[12:15], v[16:19]
    s_cmp_eq_u32 s63, 0
    s_cbranch_scc1 .LadaLN__wdone_23
    v_and_b32 v4, 63, v0
    v_lshrrev_b32 v5, 4, v4
    s_cmp_eq_u32 s63, 1
    s_cselect_b32 s46, 5, 4
    v_lshlrev_b32 v5, s46, v5
    v_and_b32 v4, 15, v4
    v_cmp_eq_u32 vcc, 0, v4
    v_mov_b32 v4, 0x7ff00000
    s_nop 0
    v_cndmask_b32 v5, v4, v5, vcc
    buffer_store_dwordx4 v[16:19], v5, s[56:59], s69 offen
.LadaLN__wdone_23:
    s_endpgm
.LadaLN__M_2:
    s_setprio 3
    s_sub_u32 s43, s2, 384
    s_lshr_b32 s63, s43, 1
    s_and_b32 s64, s43, 1
    s_cmp_ge_u32 s43, 48
    s_cbranch_scc0 .LadaLN__mset_25
    s_sub_u32 s63, s43, 24
    s_mov_b32 s64, 2
.LadaLN__mset_25:
    s_mov_b32 s48, s34
    s_mov_b32 s49, s35
    s_mov_b32 s50, 0x300000
    s_mov_b32 s51, 0x20000
    s_mov_b32 s52, s32
    s_mov_b32 s53, s33
    s_mov_b32 s54, 0x400
    s_mov_b32 s55, 0x20000
    s_mov_b32 s44, 6144
    v_lshlrev_b32 v4, 2, v0
    buffer_load_dword v8, v4, s[52:55], 0 offen
    v_and_b32 v4, 63, v0
    v_lshrrev_b32 v2, 3, v4
    v_and_b32 v3, 2, v2
    v_and_b32 v4, 7, v4
    v_xor_b32 v4, v4, v3
    v_mul_lo_u32 v2, v2, s44
    v_xor_b32 v3, 4, v4
    v_lshl_add_u32 v3, v3, 4, v2
    v_lshl_add_u32 v2, v4, 4, v2
    s_cmp_eq_u32 s64, 2
    s_cbranch_scc1 .LadaLN__ms1_26
    s_lshl_b32 s46, s42, 6
    s_lshl_b32 s47, s64, 8
    s_add_u32 s46, s46, s47
    s_mul_i32 s45, s46, s44
    s_lshl_b32 s47, s63, 7
    s_add_u32 s45, s45, s47
    s_lshl_b32 s46, s42, 13
    s_add_u32 m0, s46, 0
    s_mov_b32 s47, s45
    buffer_load_dwordx4 v2, s[48:51], s47 offen lds
    s_lshl_b32 s46, s42, 13
    s_add_u32 m0, s46, 1024
    s_lshl_b32 s46, s44, 3
    s_add_u32 s47, s47, s46
    buffer_load_dwordx4 v3, s[48:51], s47 offen lds
    s_lshl_b32 s46, s42, 13
    s_add_u32 m0, s46, 2048
    s_lshl_b32 s46, s44, 3
    s_add_u32 s47, s47, s46
    buffer_load_dwordx4 v2, s[48:51], s47 offen lds
    s_lshl_b32 s46, s42, 13
    s_add_u32 m0, s46, 3072
    s_lshl_b32 s46, s44, 3
    s_add_u32 s47, s47, s46
    buffer_load_dwordx4 v3, s[48:51], s47 offen lds
    s_lshl_b32 s46, s42, 13
    s_add_u32 m0, s46, 4096
    s_lshl_b32 s46, s44, 3
    s_add_u32 s47, s47, s46
    buffer_load_dwordx4 v2, s[48:51], s47 offen lds
    s_lshl_b32 s46, s42, 13
    s_add_u32 m0, s46, 5120
    s_lshl_b32 s46, s44, 3
    s_add_u32 s47, s47, s46
    buffer_load_dwordx4 v3, s[48:51], s47 offen lds
    s_lshl_b32 s46, s42, 13
    s_add_u32 m0, s46, 6144
    s_lshl_b32 s46, s44, 3
    s_add_u32 s47, s47, s46
    buffer_load_dwordx4 v2, s[48:51], s47 offen lds
    s_lshl_b32 s46, s42, 13
    s_add_u32 m0, s46, 7168
    s_lshl_b32 s46, s44, 3
    s_add_u32 s47, s47, s46
    buffer_load_dwordx4 v3, s[48:51], s47 offen lds
    s_branch .LadaLN__ms2_27
.LadaLN__ms1_26:
    s_lshl_b32 s46, s42, 6
    s_add_u32 s46, s46, 0
    s_mul_i32 s45, s46, s44
    s_lshl_b32 s47, s63, 7
    s_add_u32 s45, s45, s47
    s_lshl_b32 s46, s42, 13
    s_add_u32 m0, s46, 0
    s_mov_b32 s47, s45
    buffer_load_dwordx4 v2, s[48:51], s47 offen lds
    s_lshl_b32 s46, s42, 13
    s_add_u32 m0, s46, 1024
    s_lshl_b32 s46, s44, 3
    s_add_u32 s47, s47, s46
    buffer_load_dwordx4 v3, s[48:51], s47 offen lds
    s_lshl_b32 s46, s42, 13
    s_add_u32 m0, s46, 2048
    s_lshl_b32 s46, s44, 3
    s_add_u32 s47, s47, s46
    buffer_load_dwordx4 v2, s[48:51], s47 offen lds
    s_lshl_b32 s46, s42, 13
    s_add_u32 m0, s46, 3072
    s_lshl_b32 s46, s44, 3
    s_add_u32 s47, s47, s46
    buffer_load_dwordx4 v3, s[48:51], s47 offen lds
    s_lshl_b32 s46, s42, 13
    s_add_u32 m0, s46, 4096
    s_lshl_b32 s46, s44, 3
    s_add_u32 s47, s47, s46
    buffer_load_dwordx4 v2, s[48:51], s47 offen lds
    s_lshl_b32 s46, s42, 13
    s_add_u32 m0, s46, 5120
    s_lshl_b32 s46, s44, 3
    s_add_u32 s47, s47, s46
    buffer_load_dwordx4 v3, s[48:51], s47 offen lds
    s_lshl_b32 s46, s42, 13
    s_add_u32 m0, s46, 6144
    s_lshl_b32 s46, s44, 3
    s_add_u32 s47, s47, s46
    buffer_load_dwordx4 v2, s[48:51], s47 offen lds
    s_lshl_b32 s46, s42, 13
    s_add_u32 m0, s46, 7168
    s_lshl_b32 s46, s44, 3
    s_add_u32 s47, s47, s46
    buffer_load_dwordx4 v3, s[48:51], s47 offen lds
    s_lshl_b32 s46, s42, 6
    s_add_u32 s46, s46, 256
    s_mul_i32 s45, s46, s44
    s_lshl_b32 s47, s63, 7
    s_add_u32 s45, s45, s47
    s_lshl_b32 s46, s42, 13
    s_add_u32 m0, s46, 32768
    s_mov_b32 s47, s45
    buffer_load_dwordx4 v2, s[48:51], s47 offen lds
    s_lshl_b32 s46, s42, 13
    s_add_u32 m0, s46, 33792
    s_lshl_b32 s46, s44, 3
    s_add_u32 s47, s47, s46
    buffer_load_dwordx4 v3, s[48:51], s47 offen lds
    s_lshl_b32 s46, s42, 13
    s_add_u32 m0, s46, 34816
    s_lshl_b32 s46, s44, 3
    s_add_u32 s47, s47, s46
    buffer_load_dwordx4 v2, s[48:51], s47 offen lds
    s_lshl_b32 s46, s42, 13
    s_add_u32 m0, s46, 35840
    s_lshl_b32 s46, s44, 3
    s_add_u32 s47, s47, s46
    buffer_load_dwordx4 v3, s[48:51], s47 offen lds
    s_lshl_b32 s46, s42, 13
    s_add_u32 m0, s46, 36864
    s_lshl_b32 s46, s44, 3
    s_add_u32 s47, s47, s46
    buffer_load_dwordx4 v2, s[48:51], s47 offen lds
    s_lshl_b32 s46, s42, 13
    s_add_u32 m0, s46, 37888
    s_lshl_b32 s46, s44, 3
    s_add_u32 s47, s47, s46
    buffer_load_dwordx4 v3, s[48:51], s47 offen lds
    s_lshl_b32 s46, s42, 13
    s_add_u32 m0, s46, 38912
    s_lshl_b32 s46, s44, 3
    s_add_u32 s47, s47, s46
    buffer_load_dwordx4 v2, s[48:51], s47 offen lds
    s_lshl_b32 s46, s42, 13
    s_add_u32 m0, s46, 39936
    s_lshl_b32 s46, s44, 3
    s_add_u32 s47, s47, s46
    buffer_load_dwordx4 v3, s[48:51], s47 offen lds
.LadaLN__ms2_27:
    s_lshl_b32 s60, s42, 1
    s_mov_b32 s61, 0
    v_and_b32 v4, 63, v0
    v_and_b32 v6, 3, v4
    v_lshrrev_b32 v5, 1, v6
    v_add_u32 v5, s60, v5
    v_and_b32 v6, 1, v6
    v_lshlrev_b32 v6, 3, v6
    v_lshrrev_b32 v4, 2, v4
    v_and_b32 v7, 6, v4
    v_xor_b32 v5, v5, v7
    v_lshl_add_u32 v6, v5, 4, v6
    v_and_b32 v5, 3, v4
    v_lshrrev_b32 v4, 2, v4
    v_lshl_add_u32 v5, v4, 3, v5
    v_lshl_add_u32 v6, v5, 7, v6
    s_waitcnt vmcnt(8)
    v_lshlrev_b32 v10, 16, v8
    v_and_b32 v11, 0xffff0000, v8
    v_mul_f32 v12, 0xbfb8aa3b, v10
    v_mul_f32 v13, 0xbfb8aa3b, v11
    v_exp_f32 v12, v12
    v_exp_f32 v13, v13
    v_add_f32 v12, 1.0, v12
    v_add_f32 v13, 1.0, v13
    v_rcp_f32 v12, v12
    v_rcp_f32 v13, v13
    v_mul_f32 v10, v10, v12
    v_mul_f32 v11, v11, v13
    v_cvt_pk_bf16_f32 v10, v10, v11
    v_lshlrev_b32 v4, 2, v0
    v_add_u32 v4, 0x10000, v4
    ds_write_b32 v4, v10
    v_and_b32 v14, 63, v0
    v_lshrrev_b32 v14, 4, v14
    v_lshlrev_b32 v14, 4, v14
    v_add_u32 v14, 0x10000, v14
    s_lshl_b32 s46, s64, 9
    v_add_u32 v15, s46, v14
    s_waitcnt vmcnt(0) lgkmcnt(0)
    s_barrier
    s_cmp_eq_u32 s64, 2
    s_cbranch_scc1 .LadaLN__mfull_24
    s_mov_b32 s76, s38
    s_mov_b32 s77, s39
    s_mov_b32 s78, 0x100
    s_mov_b32 s79, 0x20000
    v_mov_b32 v4, 0
    buffer_load_dword v110, v4, s[76:79], 0 offen sc1
    v_mov_b32 v16, 0
    v_mov_b32 v17, 0
    v_mov_b32 v18, 0
    v_mov_b32 v19, 0
    ds_read_b64_tr_b16 v[20:21], v6 offset:0
    ds_read_b64_tr_b16 v[22:23], v6 offset:512
    ds_read_b128 v[52:55], v15 offset:0
    ds_read_b64_tr_b16 v[24:25], v6 offset:4096
    ds_read_b64_tr_b16 v[26:27], v6 offset:4608
    ds_read_b128 v[56:59], v15 offset:64
    ds_read_b64_tr_b16 v[28:29], v6 offset:8192
    ds_read_b64_tr_b16 v[30:31], v6 offset:8704
    ds_read_b128 v[60:63], v15 offset:128
    ds_read_b64_tr_b16 v[32:33], v6 offset:12288
    ds_read_b64_tr_b16 v[34:35], v6 offset:12800
    ds_read_b128 v[64:67], v15 offset:192
    ds_read_b64_tr_b16 v[36:37], v6 offset:16384
    ds_read_b64_tr_b16 v[38:39], v6 offset:16896
    ds_read_b128 v[68:71], v15 offset:256
    ds_read_b64_tr_b16 v[40:41], v6 offset:20480
    ds_read_b64_tr_b16 v[42:43], v6 offset:20992
    ds_read_b128 v[72:75], v15 offset:320
    ds_read_b64_tr_b16 v[44:45], v6 offset:24576
    ds_read_b64_tr_b16 v[46:47], v6 offset:25088
    ds_read_b128 v[76:79], v15 offset:384
    ds_read_b64_tr_b16 v[48:49], v6 offset:28672
    ds_read_b64_tr_b16 v[50:51], v6 offset:29184
    ds_read_b128 v[80:83], v15 offset:448
    s_waitcnt lgkmcnt(15)
    v_mfma_f32_16x16x32_bf16 v[16:19], v[20:23], v[52:55], v[16:19]
    v_mfma_f32_16x16x32_bf16 v[16:19], v[24:27], v[56:59], v[16:19]
    v_mfma_f32_16x16x32_bf16 v[16:19], v[28:31], v[60:63], v[16:19]
    s_waitcnt lgkmcnt(12)
    v_mfma_f32_16x16x32_bf16 v[16:19], v[32:35], v[64:67], v[16:19]
    s_waitcnt lgkmcnt(9)
    v_mfma_f32_16x16x32_bf16 v[16:19], v[36:39], v[68:71], v[16:19]
    s_waitcnt lgkmcnt(6)
    v_mfma_f32_16x16x32_bf16 v[16:19], v[40:43], v[72:75], v[16:19]
    s_waitcnt lgkmcnt(3)
    v_mfma_f32_16x16x32_bf16 v[16:19], v[44:47], v[76:79], v[16:19]
    s_waitcnt lgkmcnt(0)
    v_mfma_f32_16x16x32_bf16 v[16:19], v[48:51], v[80:83], v[16:19]
    s_add_u32 s56, s40, 0x1c0c000
    s_addc_u32 s57, s41, 0
    s_mov_b32 s58, 0x3000
    s_mov_b32 s59, 0x20000
    v_and_b32 v4, 63, v0
    v_lshrrev_b32 v5, 4, v4
    v_lshlrev_b32 v5, 4, v5
    v_and_b32 v4, 15, v4
    v_cmp_eq_u32 vcc, 0, v4
    v_mov_b32 v4, 0x7ff00000
    s_nop 0
    v_cndmask_b32 v5, v4, v5, vcc
    s_lshl_b32 s46, s63, 8
    s_lshl_b32 s47, s42, 6
    s_add_u32 s46, s46, s47
    s_mul_i32 s47, s64, 6144
    s_add_u32 s46, s46, s47
    buffer_store_dwordx4 v[16:19], v5, s[56:59], s46 offen sc1
    s_add_u32 s62, s43, 128
    s_waitcnt vmcnt(0)
    s_barrier
    s_cmp_eq_u32 s42, 0
    s_cbranch_scc0 .LadaLN__pj_28
    v_readfirstlane_b32 s3, v110
    s_nop 0
    s_cmp_lg_u32 s3, 0
    s_cbranch_scc1 .LadaLN__no_30
    s_mov_b32 s76, s38
    s_mov_b32 s77, s39
    s_mov_b32 s78, 0x100
    s_mov_b32 s79, 0x20000
    v_mov_b32 v102, 0
    s_mov_b32 s44, 0
.LadaLN__nl_29:
    buffer_load_dword v110, v102, s[76:79], 0 offen sc1
    s_waitcnt vmcnt(0)
    v_readfirstlane_b32 s3, v110
    s_add_u32 s44, s44, 1
    s_cmp_ge_u32 s44, 0x40000
    s_cbranch_scc1 .LadaLN__no_30
    s_cmp_eq_u32 s3, 0
    s_cbranch_scc1 .LadaLN__nl_29
.LadaLN__no_30:
    s_add_u32 s76, s40, 0x1d10000
    s_addc_u32 s77, s41, 0
    s_mov_b32 s78, 0x4000
    s_mov_b32 s79, 0x20000
    s_lshl_b32 s44, s62, 6
    v_mov_b32 v102, s3
    v_and_b32 v103, 63, v0
    v_cmp_eq_u32 vcc, 0, v103
    v_mov_b32 v103, 0x7ff00000
    s_nop 0
    v_cndmask_b32 v103, v103, 0, vcc
    buffer_store_dword v102, v103, s[76:79], s44 offen sc1
.LadaLN__pj_28:
    s_branch .LadaLN__mend_31
.LadaLN__mfull_24:
    v_mov_b32 v16, 0
    v_mov_b32 v17, 0
    v_mov_b32 v18, 0
    v_mov_b32 v19, 0
    ds_read_b64_tr_b16 v[20:21], v6 offset:0
    ds_read_b64_tr_b16 v[22:23], v6 offset:512
    ds_read_b128 v[52:55], v14 offset:0
    ds_read_b64_tr_b16 v[24:25], v6 offset:4096
    ds_read_b64_tr_b16 v[26:27], v6 offset:4608
    ds_read_b128 v[56:59], v14 offset:64
    ds_read_b64_tr_b16 v[28:29], v6 offset:8192
    ds_read_b64_tr_b16 v[30:31], v6 offset:8704
    ds_read_b128 v[60:63], v14 offset:128
    ds_read_b64_tr_b16 v[32:33], v6 offset:12288
    ds_read_b64_tr_b16 v[34:35], v6 offset:12800
    ds_read_b128 v[64:67], v14 offset:192
    ds_read_b64_tr_b16 v[36:37], v6 offset:16384
    ds_read_b64_tr_b16 v[38:39], v6 offset:16896
    ds_read_b128 v[68:71], v14 offset:256
    ds_read_b64_tr_b16 v[40:41], v6 offset:20480
    ds_read_b64_tr_b16 v[42:43], v6 offset:20992
    ds_read_b128 v[72:75], v14 offset:320
    ds_read_b64_tr_b16 v[44:45], v6 offset:24576
    ds_read_b64_tr_b16 v[46:47], v6 offset:25088
    ds_read_b128 v[76:79], v14 offset:384
    ds_read_b64_tr_b16 v[48:49], v6 offset:28672
    ds_read_b64_tr_b16 v[50:51], v6 offset:29184
    ds_read_b128 v[80:83], v14 offset:448
    s_waitcnt lgkmcnt(15)
    v_mfma_f32_16x16x32_bf16 v[16:19], v[20:23], v[52:55], v[16:19]
    v_mfma_f32_16x16x32_bf16 v[16:19], v[24:27], v[56:59], v[16:19]
    v_mfma_f32_16x16x32_bf16 v[16:19], v[28:31], v[60:63], v[16:19]
    s_waitcnt lgkmcnt(12)
    v_mfma_f32_16x16x32_bf16 v[16:19], v[32:35], v[64:67], v[16:19]
    s_waitcnt lgkmcnt(9)
    v_mfma_f32_16x16x32_bf16 v[16:19], v[36:39], v[68:71], v[16:19]
    s_waitcnt lgkmcnt(6)
    v_mfma_f32_16x16x32_bf16 v[16:19], v[40:43], v[72:75], v[16:19]
    s_waitcnt lgkmcnt(3)
    v_mfma_f32_16x16x32_bf16 v[16:19], v[44:47], v[76:79], v[16:19]
    s_waitcnt lgkmcnt(0)
    v_mfma_f32_16x16x32_bf16 v[16:19], v[48:51], v[80:83], v[16:19]
    ds_read_b64_tr_b16 v[20:21], v6 offset:32768
    ds_read_b64_tr_b16 v[22:23], v6 offset:33280
    ds_read_b128 v[52:55], v14 offset:512
    ds_read_b64_tr_b16 v[24:25], v6 offset:36864
    ds_read_b64_tr_b16 v[26:27], v6 offset:37376
    ds_read_b128 v[56:59], v14 offset:576
    ds_read_b64_tr_b16 v[28:29], v6 offset:40960
    ds_read_b64_tr_b16 v[30:31], v6 offset:41472
    ds_read_b128 v[60:63], v14 offset:640
    ds_read_b64_tr_b16 v[32:33], v6 offset:45056
    ds_read_b64_tr_b16 v[34:35], v6 offset:45568
    ds_read_b128 v[64:67], v14 offset:704
    ds_read_b64_tr_b16 v[36:37], v6 offset:49152
    ds_read_b64_tr_b16 v[38:39], v6 offset:49664
    ds_read_b128 v[68:71], v14 offset:768
    ds_read_b64_tr_b16 v[40:41], v6 offset:53248
    ds_read_b64_tr_b16 v[42:43], v6 offset:53760
    ds_read_b128 v[72:75], v14 offset:832
    ds_read_b64_tr_b16 v[44:45], v6 offset:57344
    ds_read_b64_tr_b16 v[46:47], v6 offset:57856
    ds_read_b128 v[76:79], v14 offset:896
    ds_read_b64_tr_b16 v[48:49], v6 offset:61440
    ds_read_b64_tr_b16 v[50:51], v6 offset:61952
    ds_read_b128 v[80:83], v14 offset:960
    s_waitcnt lgkmcnt(15)
    v_mfma_f32_16x16x32_bf16 v[16:19], v[20:23], v[52:55], v[16:19]
    v_mfma_f32_16x16x32_bf16 v[16:19], v[24:27], v[56:59], v[16:19]
    v_mfma_f32_16x16x32_bf16 v[16:19], v[28:31], v[60:63], v[16:19]
    s_waitcnt lgkmcnt(12)
    v_mfma_f32_16x16x32_bf16 v[16:19], v[32:35], v[64:67], v[16:19]
    s_waitcnt lgkmcnt(9)
    v_mfma_f32_16x16x32_bf16 v[16:19], v[36:39], v[68:71], v[16:19]
    s_waitcnt lgkmcnt(6)
    v_mfma_f32_16x16x32_bf16 v[16:19], v[40:43], v[72:75], v[16:19]
    s_waitcnt lgkmcnt(3)
    v_mfma_f32_16x16x32_bf16 v[16:19], v[44:47], v[76:79], v[16:19]
    s_waitcnt lgkmcnt(0)
    v_mfma_f32_16x16x32_bf16 v[16:19], v[48:51], v[80:83], v[16:19]
    s_lshr_b32 s62, s63, 3
    s_nop 6
    v_cvt_pk_bf16_f32 v20, v16, v17
    v_cvt_pk_bf16_f32 v21, v18, v19
    v_lshlrev_b32 v16, 16, v20
    v_and_b32 v17, 0xffff0000, v20
    v_lshlrev_b32 v18, 16, v21
    v_and_b32 v19, 0xffff0000, v21
    s_cmp_eq_u32 s62, 4
    s_cbranch_scc0 .LadaLN__mst_32
    v_add_f32 v16, 1.0, v16
    v_add_f32 v17, 1.0, v17
    v_add_f32 v18, 1.0, v18
    v_add_f32 v19, 1.0, v19
    v_cvt_pk_bf16_f32 v20, v16, v17
    v_cvt_pk_bf16_f32 v21, v18, v19
    v_lshlrev_b32 v16, 16, v20
    v_and_b32 v17, 0xffff0000, v20
    v_lshlrev_b32 v18, 16, v21
    v_and_b32 v19, 0xffff0000, v21
.LadaLN__mst_32:
    s_add_u32 s56, s40, 0x1c00000
    s_addc_u32 s57, s41, 0
    s_mov_b32 s58, 0x3000
    s_mov_b32 s59, 0x20000
    v_and_b32 v4, 63, v0
    v_lshrrev_b32 v5, 4, v4
    v_lshlrev_b32 v5, 4, v5
    v_and_b32 v4, 15, v4
    v_cmp_eq_u32 vcc, 0, v4
    v_mov_b32 v4, 0x7ff00000
    s_nop 0
    v_cndmask_b32 v5, v4, v5, vcc
    s_lshl_b32 s46, s63, 8
    s_lshl_b32 s47, s42, 6
    s_add_u32 s46, s46, s47
    buffer_store_dwordx4 v[16:19], v5, s[56:59], s46 offen
.LadaLN__mend_31:
    s_endpgm
.LadaLN__K_4:
    s_mov_b32 s46, s2
    s_lshl_b32 s44, s46, 9
    v_lshlrev_b32 v2, 1, v0
    v_add_u32 v2, s44, v2
    s_mov_b32 s48, s6
    s_mov_b32 s49, s7
    s_mov_b32 s50, 0x20000
    s_mov_b32 s51, 0x20000
    buffer_load_ushort v8, v2, s[48:51], 0 offen
    s_mov_b32 s52, s8
    s_mov_b32 s53, s9
    s_mov_b32 s54, 0x20000
    s_mov_b32 s55, 0x20000
    buffer_load_ushort v9, v2, s[52:55], 0 offen
    s_mov_b32 s56, s10
    s_mov_b32 s57, s11
    s_mov_b32 s58, 0x20000
    s_mov_b32 s59, 0x20000
    buffer_load_ushort v10, v2, s[56:59], 0 offen
    s_mov_b32 s60, s12
    s_mov_b32 s61, s13
    s_mov_b32 s62, 0x20000
    s_mov_b32 s63, 0x20000
    buffer_load_ushort v11, v2, s[60:63], 0 offen
    s_mov_b32 s64, s14
    s_mov_b32 s65, s15
    s_mov_b32 s66, 0x20000
    s_mov_b32 s67, 0x20000
    buffer_load_ushort v12, v2, s[64:67], 0 offen
    s_mov_b32 s68, s16
    s_mov_b32 s69, s17
    s_mov_b32 s70, 0x20000
    s_mov_b32 s71, 0x20000
    buffer_load_ushort v13, v2, s[68:71], 0 offen
    s_mov_b32 s72, s18
    s_mov_b32 s73, s19
    s_mov_b32 s74, 0x400
    s_mov_b32 s75, 0x20000
    v_lshrrev_b32 v3, 7, v0
    s_lshl_b32 s44, s46, 1
    v_add_u32 v3, s44, v3
    v_lshlrev_b32 v3, 1, v3
    buffer_load_ushort v14, v3, s[72:75], 0 offen
    v_lshlrev_b32 v3, 3, v0
    v_sub_u32 v3, 2047, v3
    v_subrev_u32 v116, 0, v3
    v_subrev_u32 v117, 1, v3
    v_subrev_u32 v118, 2, v3
    v_subrev_u32 v119, 3, v3
    v_subrev_u32 v120, 4, v3
    v_subrev_u32 v121, 5, v3
    v_subrev_u32 v122, 6, v3
    v_subrev_u32 v123, 7, v3
    v_subrev_u32 v124, 8, v3
    v_subrev_u32 v125, 9, v3
    v_subrev_u32 v126, 10, v3
    v_max_i32 v16, 0, v116
    v_cvt_f32_u32 v16, v16
    v_max_i32 v17, 0, v117
    v_cvt_f32_u32 v17, v17
    v_max_i32 v18, 0, v118
    v_cvt_f32_u32 v18, v18
    v_max_i32 v19, 0, v119
    v_cvt_f32_u32 v19, v19
    v_max_i32 v20, 0, v120
    v_cvt_f32_u32 v20, v20
    v_max_i32 v21, 0, v121
    v_cvt_f32_u32 v21, v21
    v_max_i32 v22, 0, v122
    v_cvt_f32_u32 v22, v22
    v_max_i32 v23, 0, v123
    v_cvt_f32_u32 v23, v23
    v_max_i32 v24, 0, v124
    v_cvt_f32_u32 v24, v24
    v_max_i32 v25, 0, v125
    v_cvt_f32_u32 v25, v25
    v_max_i32 v26, 0, v126
    v_cvt_f32_u32 v26, v26
    v_mov_b32 v27, 0
    v_cvt_pk_bf16_f32 v16, v16, v17
    v_cvt_pk_bf16_f32 v18, v18, v19
    v_cvt_pk_bf16_f32 v20, v20, v21
    v_cvt_pk_bf16_f32 v22, v22, v23
    v_cvt_pk_bf16_f32 v24, v24, v25
    v_cvt_pk_bf16_f32 v26, v26, v27
    v_lshrrev_b32 v17, 16, v16
    v_and_b32 v16, 0xffff, v16
    v_lshrrev_b32 v19, 16, v18
    v_and_b32 v18, 0xffff, v18
    v_lshrrev_b32 v21, 16, v20
    v_and_b32 v20, 0xffff, v20
    v_lshrrev_b32 v23, 16, v22
    v_and_b32 v22, 0xffff, v22
    v_lshrrev_b32 v25, 16, v24
    v_and_b32 v24, 0xffff, v24
    v_lshrrev_b32 v27, 16, v26
    v_and_b32 v26, 0xffff, v26
    v_subrev_u32 v16, 17024, v16
    v_min_i32 v116, 127, v116
    v_max_i32 v116, v116, v16
    v_lshlrev_b32 v116, 1, v116
    v_add_u32 v116, 57664, v116
    v_subrev_u32 v17, 17024, v17
    v_min_i32 v117, 127, v117
    v_max_i32 v117, v117, v17
    v_lshlrev_b32 v117, 1, v117
    v_add_u32 v117, 57664, v117
    v_subrev_u32 v18, 17024, v18
    v_min_i32 v118, 127, v118
    v_max_i32 v118, v118, v18
    v_lshlrev_b32 v118, 1, v118
    v_add_u32 v118, 57664, v118
    v_subrev_u32 v19, 17024, v19
    v_min_i32 v119, 127, v119
    v_max_i32 v119, v119, v19
    v_lshlrev_b32 v119, 1, v119
    v_add_u32 v119, 57664, v119
    v_subrev_u32 v20, 17024, v20
    v_min_i32 v120, 127, v120
    v_max_i32 v120, v120, v20
    v_lshlrev_b32 v120, 1, v120
    v_add_u32 v120, 57664, v120
    v_subrev_u32 v21, 17024, v21
    v_min_i32 v121, 127, v121
    v_max_i32 v121, v121, v21
    v_lshlrev_b32 v121, 1, v121
    v_add_u32 v121, 57664, v121
    v_subrev_u32 v22, 17024, v22
    v_min_i32 v122, 127, v122
    v_max_i32 v122, v122, v22
    v_lshlrev_b32 v122, 1, v122
    v_add_u32 v122, 57664, v122
    v_subrev_u32 v23, 17024, v23
    v_min_i32 v123, 127, v123
    v_max_i32 v123, v123, v23
    v_lshlrev_b32 v123, 1, v123
    v_add_u32 v123, 57664, v123
    v_subrev_u32 v24, 17024, v24
    v_cmp_gt_i32 vcc, 0, v124
    v_min_i32 v124, 127, v124
    v_max_i32 v124, v124, v24
    v_mov_b32 v24, 641
    v_cndmask_b32 v124, v124, v24, vcc
    v_lshlrev_b32 v124, 1, v124
    v_add_u32 v124, 57664, v124
    v_subrev_u32 v25, 17024, v25
    v_cmp_gt_i32 vcc, 0, v125
    v_min_i32 v125, 127, v125
    v_max_i32 v125, v125, v25
    v_mov_b32 v25, 641
    v_cndmask_b32 v125, v125, v25, vcc
    v_lshlrev_b32 v125, 1, v125
    v_add_u32 v125, 57664, v125
    v_subrev_u32 v26, 17024, v26
    v_cmp_gt_i32 vcc, 0, v126
    v_min_i32 v126, 127, v126
    v_max_i32 v126, v126, v26
    v_mov_b32 v26, 641
    v_cndmask_b32 v126, v126, v26, vcc
    v_lshlrev_b32 v126, 1, v126
    v_add_u32 v126, 57664, v126
    v_lshrrev_b32 v3, 7, v0
    v_mul_u32_u24 v5, 28832, v3
    v_and_b32 v3, 127, v0
    v_lshl_add_u32 v5, v3, 2, v5
    s_waitcnt vmcnt(0)
    v_lshlrev_b32 v8, 16, v8
    v_lshlrev_b32 v9, 16, v9
    v_lshlrev_b32 v10, 16, v10
    v_lshlrev_b32 v11, 16, v11
    v_lshlrev_b32 v12, 16, v12
    v_lshlrev_b32 v13, 16, v13
    v_lshlrev_b32 v14, 16, v14
    v_mul_f32 v14, 0x3fb8aa3b, v14
    v_exp_f32 v14, v14
    s_nop 0
    v_cvt_pk_bf16_f32 v14, v14, v14
    v_lshlrev_b32 v6, 16, v14
    v_mul_f32 v8, v6, v8
    v_mul_f32 v9, v6, v9
    v_mul_f32 v32, 0x3fb8aa3b, v8
    v_mul_f32 v33, 0x3e22f983, v9
    v_mul_f32 v10, v6, v10
    v_mul_f32 v11, v6, v11
    v_mov_b32 v36, v10
    v_mov_b32 v37, v11
    v_mov_b32 v38, v12
    v_mov_b32 v39, v13
    v_mul_f32 v40, 0x3f800000, v32
    v_mul_f32 v41, 0x3f800000, v33
    v_exp_f32 v40, v40
    v_fract_f32 v41, v41
    v_cos_f32 v42, v41
    v_sin_f32 v43, v41
    v_mul_f32 v42, v42, v40
    v_mul_f32 v43, v43, v40
    v_mul_f32 v40, 0x41000000, v32
    v_mul_f32 v41, 0x41000000, v33
    v_exp_f32 v40, v40
    v_fract_f32 v41, v41
    v_cos_f32 v44, v41
    v_sin_f32 v45, v41
    v_mul_f32 v44, v44, v40
    v_mul_f32 v45, v45, v40
    v_mul_f32 v40, 0x43800000, v32
    v_mul_f32 v41, 0x43800000, v33
    v_exp_f32 v40, v40
    v_fract_f32 v41, v41
    v_cos_f32 v46, v41
    v_sin_f32 v47, v41
    v_mul_f32 v46, v46, v40
    v_mul_f32 v47, v47, v40
    v_pk_mul_f32 v[34:35], v[38:39], v[36:37] op_sel_hi:[0,1]
    v_pk_fma_f32 v[34:35], v[38:39], v[36:37], v[34:35] op_sel:[1,1,0] op_sel_hi:[1,0,1] neg_lo:[1,0,0]
    v_pk_mul_f32 v[40:41], v[42:43], v[42:43] op_sel_hi:[0,1]
    v_pk_mul_f32 v[48:49], v[44:45], v[44:45] op_sel_hi:[0,1]
    v_pk_mul_f32 v[50:51], v[46:47], v[46:47] op_sel_hi:[0,1]
    v_pk_fma_f32 v[40:41], v[42:43], v[42:43], v[40:41] op_sel:[1,1,0] op_sel_hi:[1,0,1] neg_lo:[1,0,0]
    v_pk_fma_f32 v[48:49], v[44:45], v[44:45], v[48:49] op_sel:[1,1,0] op_sel_hi:[1,0,1] neg_lo:[1,0,0]
    v_pk_fma_f32 v[50:51], v[46:47], v[46:47], v[50:51] op_sel:[1,1,0] op_sel_hi:[1,0,1] neg_lo:[1,0,0]
    v_pk_mul_f32 v[52:53], v[34:35], v[42:43] op_sel_hi:[0,1]
    v_pk_mul_f32 v[54:55], v[34:35], v[40:41] op_sel_hi:[0,1]
    v_pk_mul_f32 v[66:67], v[48:49], v[44:45] op_sel_hi:[0,1]
    v_pk_mul_f32 v[68:69], v[48:49], v[48:49] op_sel_hi:[0,1]
    v_pk_mul_f32 v[70:71], v[50:51], v[46:47] op_sel_hi:[0,1]
    v_pk_mul_f32 v[72:73], v[50:51], v[50:51] op_sel_hi:[0,1]
    v_pk_fma_f32 v[52:53], v[34:35], v[42:43], v[52:53] op_sel:[1,1,0] op_sel_hi:[1,0,1] neg_lo:[1,0,0]
    v_pk_fma_f32 v[54:55], v[34:35], v[40:41], v[54:55] op_sel:[1,1,0] op_sel_hi:[1,0,1] neg_lo:[1,0,0]
    v_pk_fma_f32 v[66:67], v[48:49], v[44:45], v[66:67] op_sel:[1,1,0] op_sel_hi:[1,0,1] neg_lo:[1,0,0]
    v_pk_fma_f32 v[68:69], v[48:49], v[48:49], v[68:69] op_sel:[1,1,0] op_sel_hi:[1,0,1] neg_lo:[1,0,0]
    v_pk_fma_f32 v[70:71], v[50:51], v[46:47], v[70:71] op_sel:[1,1,0] op_sel_hi:[1,0,1] neg_lo:[1,0,0]
    v_pk_fma_f32 v[72:73], v[50:51], v[50:51], v[72:73] op_sel:[1,1,0] op_sel_hi:[1,0,1] neg_lo:[1,0,0]
    v_cvt_pk_bf16_f32 v36, v34, -v35
    ds_write_b32 v5, v36 offset:0
    v_cvt_pk_bf16_f32 v37, v52, -v53
    ds_write_b32 v5, v37 offset:544
    v_cvt_pk_bf16_f32 v38, v54, -v55
    ds_write_b32 v5, v38 offset:1088
    v_pk_mul_f32 v[56:57], v[52:53], v[40:41] op_sel_hi:[0,1]
    v_pk_mul_f32 v[58:59], v[54:55], v[40:41] op_sel_hi:[0,1]
    v_pk_mul_f32 v[74:75], v[72:73], v[46:47] op_sel_hi:[0,1]
    v_pk_mul_f32 v[76:77], v[72:73], v[50:51] op_sel_hi:[0,1]
    v_pk_mul_f32 v[78:79], v[72:73], v[70:71] op_sel_hi:[0,1]
    v_pk_mul_f32 v[80:81], v[72:73], v[72:73] op_sel_hi:[0,1]
    v_pk_fma_f32 v[56:57], v[52:53], v[40:41], v[56:57] op_sel:[1,1,0] op_sel_hi:[1,0,1] neg_lo:[1,0,0]
    v_pk_fma_f32 v[58:59], v[54:55], v[40:41], v[58:59] op_sel:[1,1,0] op_sel_hi:[1,0,1] neg_lo:[1,0,0]
    v_pk_fma_f32 v[74:75], v[72:73], v[46:47], v[74:75] op_sel:[1,1,0] op_sel_hi:[1,0,1] neg_lo:[1,0,0]
    v_pk_fma_f32 v[76:77], v[72:73], v[50:51], v[76:77] op_sel:[1,1,0] op_sel_hi:[1,0,1] neg_lo:[1,0,0]
    v_pk_fma_f32 v[78:79], v[72:73], v[70:71], v[78:79] op_sel:[1,1,0] op_sel_hi:[1,0,1] neg_lo:[1,0,0]
    v_pk_fma_f32 v[80:81], v[72:73], v[72:73], v[80:81] op_sel:[1,1,0] op_sel_hi:[1,0,1] neg_lo:[1,0,0]
    v_cvt_pk_bf16_f32 v39, v56, -v57
    ds_write_b32 v5, v39 offset:1632
    v_cvt_pk_bf16_f32 v36, v58, -v59
    ds_write_b32 v5, v36 offset:2176
    v_mov_b32 v82, 1.0
    v_mov_b32 v83, 0
    v_cvt_pk_bf16_f32 v37, v82, v83
    ds_write_b32 v5, v37 offset:11424
    v_cvt_pk_bf16_f32 v38, v44, v45
    ds_write_b32 v5, v38 offset:11968
    v_cvt_pk_bf16_f32 v39, v48, v49
    ds_write_b32 v5, v39 offset:12512
    v_cvt_pk_bf16_f32 v36, v66, v67
    ds_write_b32 v5, v36 offset:13056
    v_pk_mul_f32 v[60:61], v[56:57], v[40:41] op_sel_hi:[0,1]
    v_pk_mul_f32 v[62:63], v[58:59], v[40:41] op_sel_hi:[0,1]
    v_pk_fma_f32 v[60:61], v[56:57], v[40:41], v[60:61] op_sel:[1,1,0] op_sel_hi:[1,0,1] neg_lo:[1,0,0]
    v_pk_fma_f32 v[62:63], v[58:59], v[40:41], v[62:63] op_sel:[1,1,0] op_sel_hi:[1,0,1] neg_lo:[1,0,0]
    v_pk_mul_f32 v[84:85], v[82:83], v[68:69] op_sel_hi:[0,1]
    v_pk_mul_f32 v[86:87], v[44:45], v[68:69] op_sel_hi:[0,1]
    v_pk_mul_f32 v[88:89], v[48:49], v[68:69] op_sel_hi:[0,1]
    v_pk_mul_f32 v[90:91], v[66:67], v[68:69] op_sel_hi:[0,1]
    v_pk_fma_f32 v[84:85], v[82:83], v[68:69], v[84:85] op_sel:[1,1,0] op_sel_hi:[1,0,1] neg_lo:[1,0,0]
    v_pk_fma_f32 v[86:87], v[44:45], v[68:69], v[86:87] op_sel:[1,1,0] op_sel_hi:[1,0,1] neg_lo:[1,0,0]
    v_pk_fma_f32 v[88:89], v[48:49], v[68:69], v[88:89] op_sel:[1,1,0] op_sel_hi:[1,0,1] neg_lo:[1,0,0]
    v_pk_fma_f32 v[90:91], v[66:67], v[68:69], v[90:91] op_sel:[1,1,0] op_sel_hi:[1,0,1] neg_lo:[1,0,0]
    v_cvt_pk_bf16_f32 v37, v60, -v61
    ds_write_b32 v5, v37 offset:2720
    v_cvt_pk_bf16_f32 v38, v62, -v63
    ds_write_b32 v5, v38 offset:3264
    v_pk_mul_f32 v[64:65], v[60:61], v[40:41] op_sel_hi:[0,1]
    v_pk_mul_f32 v[100:101], v[34:35], v[46:47] op_sel_hi:[0,1]
    v_pk_mul_f32 v[102:103], v[54:55], v[46:47] op_sel_hi:[0,1]
    v_pk_mul_f32 v[104:105], v[58:59], v[46:47] op_sel_hi:[0,1]
    v_pk_mul_f32 v[106:107], v[62:63], v[46:47] op_sel_hi:[0,1]
    v_pk_fma_f32 v[64:65], v[60:61], v[40:41], v[64:65] op_sel:[1,1,0] op_sel_hi:[1,0,1] neg_lo:[1,0,0]
    v_pk_fma_f32 v[100:101], v[34:35], v[46:47], v[100:101] op_sel:[1,1,0] op_sel_hi:[1,0,1] neg_lo:[1,0,0]
    v_pk_fma_f32 v[102:103], v[54:55], v[46:47], v[102:103] op_sel:[1,1,0] op_sel_hi:[1,0,1] neg_lo:[1,0,0]
    v_pk_fma_f32 v[104:105], v[58:59], v[46:47], v[104:105] op_sel:[1,1,0] op_sel_hi:[1,0,1] neg_lo:[1,0,0]
    v_pk_fma_f32 v[106:107], v[62:63], v[46:47], v[106:107] op_sel:[1,1,0] op_sel_hi:[1,0,1] neg_lo:[1,0,0]
    v_cvt_pk_bf16_f32 v39, v84, v85
    ds_write_b32 v5, v39 offset:13600
    v_cvt_pk_bf16_f32 v36, v86, v87
    ds_write_b32 v5, v36 offset:14144
    v_cvt_pk_bf16_f32 v37, v88, v89
    ds_write_b32 v5, v37 offset:14688
    v_cvt_pk_bf16_f32 v38, v90, v91
    ds_write_b32 v5, v38 offset:15232
    v_cvt_pk_bf16_f32 v39, v64, -v65
    ds_write_b32 v5, v39 offset:3808
    v_cvt_pk_bf16_f32 v36, v100, -v101
    ds_write_b32 v5, v36 offset:4352
    v_cvt_pk_bf16_f32 v37, v102, -v103
    ds_write_b32 v5, v37 offset:4896
    v_cvt_pk_bf16_f32 v38, v104, -v105
    ds_write_b32 v5, v38 offset:5440
    v_cvt_pk_bf16_f32 v39, v106, -v107
    ds_write_b32 v5, v39 offset:5984
    v_pk_mul_f32 v[92:93], v[84:85], v[68:69] op_sel_hi:[0,1]
    v_pk_mul_f32 v[94:95], v[86:87], v[68:69] op_sel_hi:[0,1]
    v_pk_mul_f32 v[96:97], v[88:89], v[68:69] op_sel_hi:[0,1]
    v_pk_mul_f32 v[98:99], v[90:91], v[68:69] op_sel_hi:[0,1]
    v_pk_mul_f32 v[100:101], v[34:35], v[50:51] op_sel_hi:[0,1]
    v_pk_mul_f32 v[102:103], v[58:59], v[50:51] op_sel_hi:[0,1]
    v_pk_mul_f32 v[104:105], v[34:35], v[70:71] op_sel_hi:[0,1]
    v_pk_mul_f32 v[106:107], v[58:59], v[70:71] op_sel_hi:[0,1]
    v_pk_fma_f32 v[92:93], v[84:85], v[68:69], v[92:93] op_sel:[1,1,0] op_sel_hi:[1,0,1] neg_lo:[1,0,0]
    v_pk_fma_f32 v[94:95], v[86:87], v[68:69], v[94:95] op_sel:[1,1,0] op_sel_hi:[1,0,1] neg_lo:[1,0,0]
    v_pk_fma_f32 v[96:97], v[88:89], v[68:69], v[96:97] op_sel:[1,1,0] op_sel_hi:[1,0,1] neg_lo:[1,0,0]
    v_pk_fma_f32 v[98:99], v[90:91], v[68:69], v[98:99] op_sel:[1,1,0] op_sel_hi:[1,0,1] neg_lo:[1,0,0]
    v_pk_fma_f32 v[100:101], v[34:35], v[50:51], v[100:101] op_sel:[1,1,0] op_sel_hi:[1,0,1] neg_lo:[1,0,0]
    v_pk_fma_f32 v[102:103], v[58:59], v[50:51], v[102:103] op_sel:[1,1,0] op_sel_hi:[1,0,1] neg_lo:[1,0,0]
    v_pk_fma_f32 v[104:105], v[34:35], v[70:71], v[104:105] op_sel:[1,1,0] op_sel_hi:[1,0,1] neg_lo:[1,0,0]
    v_pk_fma_f32 v[106:107], v[58:59], v[70:71], v[106:107] op_sel:[1,1,0] op_sel_hi:[1,0,1] neg_lo:[1,0,0]
    v_cvt_pk_bf16_f32 v36, v92, v93
    ds_write_b32 v5, v36 offset:15776
    v_cvt_pk_bf16_f32 v37, v94, v95
    ds_write_b32 v5, v37 offset:16320
    v_cvt_pk_bf16_f32 v38, v96, v97
    ds_write_b32 v5, v38 offset:16864
    v_cvt_pk_bf16_f32 v39, v98, v99
    ds_write_b32 v5, v39 offset:17408
    v_cvt_pk_bf16_f32 v36, v100, -v101
    ds_write_b32 v5, v36 offset:6528
    v_cvt_pk_bf16_f32 v37, v102, -v103
    ds_write_b32 v5, v37 offset:7072
    v_cvt_pk_bf16_f32 v38, v104, -v105
    ds_write_b32 v5, v38 offset:7616
    v_cvt_pk_bf16_f32 v39, v106, -v107
    ds_write_b32 v5, v39 offset:8160
    v_pk_mul_f32 v[84:85], v[92:93], v[68:69] op_sel_hi:[0,1]
    v_pk_mul_f32 v[86:87], v[94:95], v[68:69] op_sel_hi:[0,1]
    v_pk_mul_f32 v[88:89], v[96:97], v[68:69] op_sel_hi:[0,1]
    v_pk_mul_f32 v[90:91], v[98:99], v[68:69] op_sel_hi:[0,1]
    v_pk_mul_f32 v[100:101], v[34:35], v[72:73] op_sel_hi:[0,1]
    v_pk_mul_f32 v[102:103], v[34:35], v[74:75] op_sel_hi:[0,1]
    v_pk_mul_f32 v[104:105], v[34:35], v[76:77] op_sel_hi:[0,1]
    v_pk_mul_f32 v[106:107], v[34:35], v[78:79] op_sel_hi:[0,1]
    v_pk_fma_f32 v[84:85], v[92:93], v[68:69], v[84:85] op_sel:[1,1,0] op_sel_hi:[1,0,1] neg_lo:[1,0,0]
    v_pk_fma_f32 v[86:87], v[94:95], v[68:69], v[86:87] op_sel:[1,1,0] op_sel_hi:[1,0,1] neg_lo:[1,0,0]
    v_pk_fma_f32 v[88:89], v[96:97], v[68:69], v[88:89] op_sel:[1,1,0] op_sel_hi:[1,0,1] neg_lo:[1,0,0]
    v_pk_fma_f32 v[90:91], v[98:99], v[68:69], v[90:91] op_sel:[1,1,0] op_sel_hi:[1,0,1] neg_lo:[1,0,0]
    v_pk_fma_f32 v[100:101], v[34:35], v[72:73], v[100:101] op_sel:[1,1,0] op_sel_hi:[1,0,1] neg_lo:[1,0,0]
    v_pk_fma_f32 v[102:103], v[34:35], v[74:75], v[102:103] op_sel:[1,1,0] op_sel_hi:[1,0,1] neg_lo:[1,0,0]
    v_pk_fma_f32 v[104:105], v[34:35], v[76:77], v[104:105] op_sel:[1,1,0] op_sel_hi:[1,0,1] neg_lo:[1,0,0]
    v_pk_fma_f32 v[106:107], v[34:35], v[78:79], v[106:107] op_sel:[1,1,0] op_sel_hi:[1,0,1] neg_lo:[1,0,0]
    v_cvt_pk_bf16_f32 v36, v84, v85
    ds_write_b32 v5, v36 offset:17952
    v_cvt_pk_bf16_f32 v37, v86, v87
    ds_write_b32 v5, v37 offset:18496
    v_cvt_pk_bf16_f32 v38, v88, v89
    ds_write_b32 v5, v38 offset:19040
    v_cvt_pk_bf16_f32 v39, v90, v91
    ds_write_b32 v5, v39 offset:19584
    v_cvt_pk_bf16_f32 v36, v100, -v101
    ds_write_b32 v5, v36 offset:8704
    v_cvt_pk_bf16_f32 v37, v102, -v103
    ds_write_b32 v5, v37 offset:9248
    v_cvt_pk_bf16_f32 v38, v104, -v105
    ds_write_b32 v5, v38 offset:9792
    v_cvt_pk_bf16_f32 v39, v106, -v107
    ds_write_b32 v5, v39 offset:10336
    v_pk_mul_f32 v[92:93], v[84:85], v[68:69] op_sel_hi:[0,1]
    v_pk_mul_f32 v[94:95], v[86:87], v[68:69] op_sel_hi:[0,1]
    v_pk_mul_f32 v[96:97], v[88:89], v[68:69] op_sel_hi:[0,1]
    v_pk_mul_f32 v[98:99], v[90:91], v[68:69] op_sel_hi:[0,1]
    v_pk_mul_f32 v[100:101], v[34:35], v[80:81] op_sel_hi:[0,1]
    v_pk_fma_f32 v[92:93], v[84:85], v[68:69], v[92:93] op_sel:[1,1,0] op_sel_hi:[1,0,1] neg_lo:[1,0,0]
    v_pk_fma_f32 v[94:95], v[86:87], v[68:69], v[94:95] op_sel:[1,1,0] op_sel_hi:[1,0,1] neg_lo:[1,0,0]
    v_pk_fma_f32 v[96:97], v[88:89], v[68:69], v[96:97] op_sel:[1,1,0] op_sel_hi:[1,0,1] neg_lo:[1,0,0]
    v_pk_fma_f32 v[98:99], v[90:91], v[68:69], v[98:99] op_sel:[1,1,0] op_sel_hi:[1,0,1] neg_lo:[1,0,0]
    v_pk_fma_f32 v[100:101], v[34:35], v[80:81], v[100:101] op_sel:[1,1,0] op_sel_hi:[1,0,1] neg_lo:[1,0,0]
    v_cvt_pk_bf16_f32 v36, v92, v93
    ds_write_b32 v5, v36 offset:20128
    v_cvt_pk_bf16_f32 v37, v94, v95
    ds_write_b32 v5, v37 offset:20672
    v_cvt_pk_bf16_f32 v38, v96, v97
    ds_write_b32 v5, v38 offset:21216
    v_cvt_pk_bf16_f32 v39, v98, v99
    ds_write_b32 v5, v39 offset:21760
    v_cvt_pk_bf16_f32 v36, v100, -v101
    ds_write_b32 v5, v36 offset:10880
    v_pk_mul_f32 v[84:85], v[92:93], v[68:69] op_sel_hi:[0,1]
    v_pk_mul_f32 v[86:87], v[94:95], v[68:69] op_sel_hi:[0,1]
    v_pk_mul_f32 v[88:89], v[96:97], v[68:69] op_sel_hi:[0,1]
    v_pk_mul_f32 v[90:91], v[98:99], v[68:69] op_sel_hi:[0,1]
    v_pk_fma_f32 v[84:85], v[92:93], v[68:69], v[84:85] op_sel:[1,1,0] op_sel_hi:[1,0,1] neg_lo:[1,0,0]
    v_pk_fma_f32 v[86:87], v[94:95], v[68:69], v[86:87] op_sel:[1,1,0] op_sel_hi:[1,0,1] neg_lo:[1,0,0]
    v_pk_fma_f32 v[88:89], v[96:97], v[68:69], v[88:89] op_sel:[1,1,0] op_sel_hi:[1,0,1] neg_lo:[1,0,0]
    v_pk_fma_f32 v[90:91], v[98:99], v[68:69], v[90:91] op_sel:[1,1,0] op_sel_hi:[1,0,1] neg_lo:[1,0,0]
    v_cvt_pk_bf16_f32 v37, v84, v85
    ds_write_b32 v5, v37 offset:22304
    v_cvt_pk_bf16_f32 v38, v86, v87
    ds_write_b32 v5, v38 offset:22848
    v_cvt_pk_bf16_f32 v39, v88, v89
    ds_write_b32 v5, v39 offset:23392
    v_cvt_pk_bf16_f32 v36, v90, v91
    ds_write_b32 v5, v36 offset:23936
    v_pk_mul_f32 v[92:93], v[84:85], v[68:69] op_sel_hi:[0,1]
    v_pk_mul_f32 v[94:95], v[86:87], v[68:69] op_sel_hi:[0,1]
    v_pk_mul_f32 v[96:97], v[88:89], v[68:69] op_sel_hi:[0,1]
    v_pk_mul_f32 v[98:99], v[90:91], v[68:69] op_sel_hi:[0,1]
    v_pk_fma_f32 v[92:93], v[84:85], v[68:69], v[92:93] op_sel:[1,1,0] op_sel_hi:[1,0,1] neg_lo:[1,0,0]
    v_pk_fma_f32 v[94:95], v[86:87], v[68:69], v[94:95] op_sel:[1,1,0] op_sel_hi:[1,0,1] neg_lo:[1,0,0]
    v_pk_fma_f32 v[96:97], v[88:89], v[68:69], v[96:97] op_sel:[1,1,0] op_sel_hi:[1,0,1] neg_lo:[1,0,0]
    v_pk_fma_f32 v[98:99], v[90:91], v[68:69], v[98:99] op_sel:[1,1,0] op_sel_hi:[1,0,1] neg_lo:[1,0,0]
    v_cvt_pk_bf16_f32 v37, v92, v93
    ds_write_b32 v5, v37 offset:24480
    v_cvt_pk_bf16_f32 v38, v94, v95
    ds_write_b32 v5, v38 offset:25024
    v_cvt_pk_bf16_f32 v39, v96, v97
    ds_write_b32 v5, v39 offset:25568
    v_cvt_pk_bf16_f32 v36, v98, v99
    ds_write_b32 v5, v36 offset:26112
    v_pk_mul_f32 v[84:85], v[92:93], v[68:69] op_sel_hi:[0,1]
    v_pk_mul_f32 v[86:87], v[94:95], v[68:69] op_sel_hi:[0,1]
    v_pk_mul_f32 v[88:89], v[96:97], v[68:69] op_sel_hi:[0,1]
    v_pk_mul_f32 v[90:91], v[98:99], v[68:69] op_sel_hi:[0,1]
    v_pk_fma_f32 v[84:85], v[92:93], v[68:69], v[84:85] op_sel:[1,1,0] op_sel_hi:[1,0,1] neg_lo:[1,0,0]
    v_pk_fma_f32 v[86:87], v[94:95], v[68:69], v[86:87] op_sel:[1,1,0] op_sel_hi:[1,0,1] neg_lo:[1,0,0]
    v_pk_fma_f32 v[88:89], v[96:97], v[68:69], v[88:89] op_sel:[1,1,0] op_sel_hi:[1,0,1] neg_lo:[1,0,0]
    v_pk_fma_f32 v[90:91], v[98:99], v[68:69], v[90:91] op_sel:[1,1,0] op_sel_hi:[1,0,1] neg_lo:[1,0,0]
    v_cvt_pk_bf16_f32 v37, v84, v85
    ds_write_b32 v5, v37 offset:26656
    v_cvt_pk_bf16_f32 v38, v86, v87
    ds_write_b32 v5, v38 offset:27200
    v_cvt_pk_bf16_f32 v39, v88, v89
    ds_write_b32 v5, v39 offset:27744
    v_cvt_pk_bf16_f32 v36, v90, v91
    ds_write_b32 v5, v36 offset:28288
    s_waitcnt lgkmcnt(0)
    s_barrier
    v_and_b32 v3, 63, v0
    v_and_b32 v4, 15, v3
    v_lshrrev_b32 v3, 4, v3
    s_lshr_b32 s44, s42, 1
    s_mul_i32 s44, s44, 28832
    v_mul_u32_u24 v2, 544, v4
    v_lshl_add_u32 v2, v3, 4, v2
    v_add_u32 v2, s44, v2
    s_and_b32 s45, s42, 1
    s_mul_i32 s45, s45, 8704
    s_add_u32 s45, s45, 11424
    v_add_u32 v5, s45, v2
    ds_read_b128 a[0:3], v2 offset:0
    ds_read_b128 a[4:7], v2 offset:8704
    ds_read_b128 a[64:67], v5 offset:0
    ds_read_b128 a[8:11], v2 offset:64
    ds_read_b128 a[12:15], v2 offset:8768
    ds_read_b128 a[68:71], v5 offset:64
    ds_read_b128 a[16:19], v2 offset:128
    ds_read_b128 a[20:23], v2 offset:8832
    ds_read_b128 a[72:75], v5 offset:128
    ds_read_b128 a[24:27], v2 offset:192
    ds_read_b128 a[28:31], v2 offset:8896
    ds_read_b128 a[76:79], v5 offset:192
    ds_read_b128 a[32:35], v2 offset:256
    ds_read_b128 a[36:39], v2 offset:8960
    ds_read_b128 a[80:83], v5 offset:256
    ds_read_b128 a[40:43], v2 offset:320
    ds_read_b128 a[44:47], v2 offset:9024
    ds_read_b128 a[84:87], v5 offset:320
    ds_read_b128 a[48:51], v2 offset:384
    ds_read_b128 a[52:55], v2 offset:9088
    ds_read_b128 a[88:91], v5 offset:384
    ds_read_b128 a[56:59], v2 offset:448
    ds_read_b128 a[60:63], v2 offset:9152
    ds_read_b128 a[92:95], v5 offset:448
    v_mov_b32 v48, 0
    v_mov_b32 v49, 0
    v_mov_b32 v50, 0
    v_mov_b32 v51, 0
    v_mov_b32 v52, 0
    v_mov_b32 v53, 0
    v_mov_b32 v54, 0
    v_mov_b32 v55, 0
    s_and_b32 s45, s42, 1
    s_lshl_b32 s45, s45, 4
    v_add_u32 v6, s45, v4
    v_sub_u32 v7, 4, v3
    v_min_u32 v7, 3, v7
    v_lshlrev_b32 v7, v7, v6
    v_lshlrev_b32 v32, 2, v3
    v_mov_b32 v33, 256
    v_cmp_eq_u32 vcc, 2, v3
    s_nop 1
    v_cndmask_b32 v32, v32, v33, vcc
    v_mov_b32 v33, 384
    v_cmp_eq_u32 vcc, 3, v3
    s_nop 1
    v_cndmask_b32 v32, v32, v33, vcc
    v_add_u32 v32, v32, v7
    v_mov_b32 v33, 0
    v_mov_b32 v34, 62
    v_cndmask_b32 v33, v33, v34, vcc
    v_add_u32 v33, v32, v33
    v_add_u32 v34, 512, v6
    v_mov_b32 v7, 644
    v_cmp_eq_u32 vcc, 0, v3
    s_nop 1
    v_cndmask_b32 v34, v7, v34, vcc
    v_lshl_add_u32 v7, v3, 5, v6
    v_cmp_eq_u32 vcc, 32, v7
    v_mov_b32 v7, 640
    s_nop 0
    v_cndmask_b32 v34, v34, v7, vcc
    s_lshr_b32 s44, s42, 1
    s_mul_i32 s44, s44, 1536
    s_add_u32 s44, s44, 57664
    v_lshl_add_u32 v32, v32, 1, s44
    v_lshl_add_u32 v33, v33, 1, s44
    v_lshl_add_u32 v34, v34, 1, s44
    s_waitcnt lgkmcnt(15)
    v_mfma_f32_16x16x32_bf16 v[48:51], a[0:3], a[64:67], v[48:51]
    v_mfma_f32_16x16x32_bf16 v[52:55], a[4:7], a[64:67], v[52:55]
    v_mfma_f32_16x16x32_bf16 v[48:51], a[8:11], a[68:71], v[48:51]
    v_mfma_f32_16x16x32_bf16 v[52:55], a[12:15], a[68:71], v[52:55]
    v_mfma_f32_16x16x32_bf16 v[48:51], a[16:19], a[72:75], v[48:51]
    v_mfma_f32_16x16x32_bf16 v[52:55], a[20:23], a[72:75], v[52:55]
    s_waitcnt lgkmcnt(12)
    v_mfma_f32_16x16x32_bf16 v[48:51], a[24:27], a[76:79], v[48:51]
    v_mfma_f32_16x16x32_bf16 v[52:55], a[28:31], a[76:79], v[52:55]
    s_waitcnt lgkmcnt(9)
    v_mfma_f32_16x16x32_bf16 v[48:51], a[32:35], a[80:83], v[48:51]
    v_mfma_f32_16x16x32_bf16 v[52:55], a[36:39], a[80:83], v[52:55]
    s_waitcnt lgkmcnt(6)
    v_mfma_f32_16x16x32_bf16 v[48:51], a[40:43], a[84:87], v[48:51]
    v_mfma_f32_16x16x32_bf16 v[52:55], a[44:47], a[84:87], v[52:55]
    s_waitcnt lgkmcnt(3)
    v_mfma_f32_16x16x32_bf16 v[48:51], a[48:51], a[88:91], v[48:51]
    v_mfma_f32_16x16x32_bf16 v[52:55], a[52:55], a[88:91], v[52:55]
    s_waitcnt lgkmcnt(0)
    v_mfma_f32_16x16x32_bf16 v[48:51], a[56:59], a[92:95], v[48:51]
    v_mfma_f32_16x16x32_bf16 v[52:55], a[60:63], a[92:95], v[52:55]
    s_nop 6
    v_cvt_pk_bf16_f32 v40, v48, v49
    v_cvt_pk_bf16_f32 v41, v50, v51
    v_cvt_pk_bf16_f32 v42, v52, v53
    v_cvt_pk_bf16_f32 v43, v54, v55
    ds_write_b16 v32, v40
    ds_write_b16_d16_hi v32, v40 offset:2
    ds_write_b16 v33, v41 offset:4
    ds_write_b16_d16_hi v33, v41 offset:6
    ds_write_b16 v34, v42
    ds_write_b16_d16_hi v34, v42 offset:64
    ds_write_b16 v34, v43 offset:128
    ds_write_b16_d16_hi v34, v43 offset:192
    s_add_u32 s44, s44, 1282
    v_mov_b32 v44, s44
    v_mov_b32 v45, 0
    ds_write_b16 v44, v45
    s_waitcnt lgkmcnt(0)
    s_barrier
    s_mov_b32 s76, s38
    s_mov_b32 s77, s39
    s_mov_b32 s78, 0x100
    s_mov_b32 s79, 0x20000
    v_mov_b32 v5, 0
    buffer_load_dword v127, v5, s[76:79], 0 offen sc1
    ds_read_u16 v16, v116 offset:0
    ds_read_u16 v17, v117 offset:0
    ds_read_u16 v18, v118 offset:0
    ds_read_u16 v19, v119 offset:0
    ds_read_u16 v20, v120 offset:0
    ds_read_u16 v21, v121 offset:0
    ds_read_u16 v22, v122 offset:0
    ds_read_u16 v23, v123 offset:0
    ds_read_u16 v24, v124 offset:0
    ds_read_u16 v25, v125 offset:0
    ds_read_u16 v26, v126 offset:0
    ds_read_u16 v27, v116 offset:1536
    ds_read_u16 v28, v117 offset:1536
    ds_read_u16 v29, v118 offset:1536
    ds_read_u16 v30, v119 offset:1536
    ds_read_u16 v31, v120 offset:1536
    ds_read_u16 v32, v121 offset:1536
    ds_read_u16 v33, v122 offset:1536
    ds_read_u16 v34, v123 offset:1536
    ds_read_u16 v35, v124 offset:1536
    ds_read_u16 v36, v125 offset:1536
    ds_read_u16 v37, v126 offset:1536
    v_lshlrev_b32 v6, 4, v0
    s_waitcnt lgkmcnt(0)
    v_lshl_or_b32 v56, v17, 16, v16
    v_lshl_or_b32 v57, v19, 16, v18
    v_lshl_or_b32 v58, v21, 16, v20
    v_lshl_or_b32 v59, v23, 16, v22
    ds_write_b128 v6, v[56:59] offset:0
    v_lshl_or_b32 v60, v18, 16, v17
    v_lshl_or_b32 v61, v20, 16, v19
    v_lshl_or_b32 v62, v22, 16, v21
    v_lshl_or_b32 v63, v24, 16, v23
    ds_write_b128 v6, v[60:63] offset:4160
    v_lshl_or_b32 v64, v19, 16, v18
    v_lshl_or_b32 v65, v21, 16, v20
    v_lshl_or_b32 v66, v23, 16, v22
    v_lshl_or_b32 v67, v25, 16, v24
    ds_write_b128 v6, v[64:67] offset:8320
    v_lshl_or_b32 v68, v20, 16, v19
    v_lshl_or_b32 v69, v22, 16, v21
    v_lshl_or_b32 v70, v24, 16, v23
    v_lshl_or_b32 v71, v26, 16, v25
    ds_write_b128 v6, v[68:71] offset:12480
    v_lshl_or_b32 v72, v28, 16, v27
    v_lshl_or_b32 v73, v30, 16, v29
    v_lshl_or_b32 v74, v32, 16, v31
    v_lshl_or_b32 v75, v34, 16, v33
    ds_write_b128 v6, v[72:75] offset:16640
    v_lshl_or_b32 v76, v29, 16, v28
    v_lshl_or_b32 v77, v31, 16, v30
    v_lshl_or_b32 v78, v33, 16, v32
    v_lshl_or_b32 v79, v35, 16, v34
    ds_write_b128 v6, v[76:79] offset:20800
    v_lshl_or_b32 v80, v30, 16, v29
    v_lshl_or_b32 v81, v32, 16, v31
    v_lshl_or_b32 v82, v34, 16, v33
    v_lshl_or_b32 v83, v36, 16, v35
    ds_write_b128 v6, v[80:83] offset:24960
    v_lshl_or_b32 v84, v31, 16, v30
    v_lshl_or_b32 v85, v33, 16, v32
    v_lshl_or_b32 v86, v35, 16, v34
    v_lshl_or_b32 v87, v37, 16, v36
    ds_write_b128 v6, v[84:87] offset:29120
    s_add_u32 s52, s40, 0x2100000
    s_addc_u32 s53, s41, 0
    s_mov_b32 s54, 0x204000
    s_mov_b32 s55, 0x20000
    s_add_u32 s56, s40, 0x1e00000
    s_addc_u32 s57, s41, 0
    s_mov_b32 s58, 0x204000
    s_mov_b32 s59, 0x20000
    s_add_u32 s64, s40, 0x1c0c000
    s_addc_u32 s65, s41, 0
    s_mov_b32 s66, 0x3000
    s_mov_b32 s67, 0x20000
    s_mov_b32 s68, s20
    s_mov_b32 s69, s21
    s_mov_b32 s70, 0x400
    s_mov_b32 s71, 0x20000
    s_add_u32 s72, s40, 0x2400000
    s_addc_u32 s73, s41, 0
    s_mov_b32 s74, 0x204000
    s_mov_b32 s75, 0x20000
    s_lshr_b32 s60, s42, 1
    s_and_b32 s47, s42, 1
    s_lshl_b32 s46, s2, 1
    s_add_u32 s46, s46, s60
    v_and_b32 v2, 63, v0
    s_lshl_b32 s44, s47, 11
    v_lshl_add_u32 v3, v2, 4, s44
    s_lshl_b32 s44, s46, 1
    v_mov_b32 v5, s44
    buffer_load_ushort v46, v5, s[68:71], 0 offen
    v_and_b32 v4, 15, v2
    v_lshrrev_b32 v5, 4, v2
    v_lshlrev_b32 v6, 5, v4
    v_lshl_add_u32 v6, v5, 3, v6
    s_lshl_b32 s44, s47, 11
    v_add_u32 v6, s44, v6
    s_mul_i32 s44, s60, 16640
    v_add_u32 v56, s44, v3
    s_mul_i32 s61, s60, 4608
    s_add_u32 s61, s61, 33280
    v_add_u32 v57, s61, v3
    v_sub_u32 v58, 3, v4
    v_and_b32 v58, 3, v58
    v_mul_u32_u24 v58, 4160, v58
    v_lshrrev_b32 v59, 2, v4
    v_lshlrev_b32 v59, 3, v59
    v_sub_u32 v58, v58, v59
    v_lshl_add_u32 v58, v5, 4, v58
    s_lshl_b32 s45, s47, 6
    s_sub_u32 s45, 88, s45
    s_add_u32 s44, s44, s45
    v_add_u32 v58, s44, v58
    v_lshlrev_b32 v59, 5, v4
    v_lshl_add_u32 v59, v5, 4, v59
    s_lshl_b32 s45, s47, 6
    s_sub_u32 s45, 64, s45
    s_add_u32 s45, s45, s61
    v_add_u32 v59, s45, v59
    v_add_u32 v60, s61, v6
    v_mov_b32 v64, 0
    v_mov_b32 v65, 0
    v_mov_b32 v66, 0
    v_mov_b32 v67, 0
    s_cmp_eq_u32 s47, 0
    s_cbranch_scc0 .LadaLN__z1_33
    v_lshrrev_b32 v68, 1, v2
    v_mul_u32_u24 v68, 4160, v68
    v_and_b32 v69, 1, v2
    v_lshl_add_u32 v68, v69, 4, v68
    s_mul_i32 s44, s60, 16640
    v_add_u32 v68, s44, v68
    s_mov_b64 exec, 0xff
    ds_write_b128 v68, v[64:67] offset:4096
    s_mov_b64 exec, -1
    s_branch .LadaLN__z2_34
.LadaLN__z1_33:
    v_lshlrev_b32 v68, 4, v2
    v_add_u32 v68, s61, v68
    s_mov_b64 exec, 0x3fffffff
    ds_write_b128 v68, v[64:67]
    s_mov_b64 exec, -1
.LadaLN__z2_34:
    v_lshrrev_b32 v61, 2, v2
    s_lshl_b32 s44, s42, 5
    v_add_u32 v61, s44, v61
    v_and_b32 v64, 1, v2
    v_lshl_add_u32 v63, v61, 1, v64
    v_lshlrev_b32 v63, 4, v63
    v_bfe_u32 v64, v2, 1, 1
    v_mul_u32_u24 v57, 4608, v64
    v_add_u32 v57, 33280, v57
    v_add_u32 v57, v63, v57
    v_lshl_add_u32 v63, v64, 12, v63
    v_add_u32 v63, 58880, v63
    v_mul_u32_u24 v61, 16512, v61
    v_and_b32 v65, 3, v2
    v_lshl_add_u32 v61, v65, 4, v61
    s_lshl_b32 s44, s2, 3
    v_lshl_add_u32 v65, v64, 2, s44
    s_lshl_b32 s44, s46, 2
    v_mov_b32 v66, s44
    s_lshl_b32 s44, s60, 12
    s_add_u32 s44, s44, 58880
    v_add_u32 v67, s44, v6
    v_and_b32 v62, 15, v2
    v_lshrrev_b32 v62, 1, v62
    s_lshl_b32 s44, s47, 5
    v_add_u32 v62, s44, v62
    v_mul_u32_u24 v62, 33024, v62
    v_and_b32 v64, 1, v2
    v_lshl_add_u32 v62, v64, 5, v62
    v_lshrrev_b32 v64, 4, v2
    v_lshl_add_u32 v62, v64, 3, v62
    s_lshr_b32 s63, s2, 5
    s_setprio 2
    s_waitcnt vmcnt(1)
    s_cmp_eq_u32 s42, 0
    s_cbranch_scc0 .LadaLN__aw_35
    v_readfirstlane_b32 s3, v127
    s_nop 0
    s_cmp_lg_u32 s3, 0
    s_cbranch_scc1 .LadaLN__no_39
    s_mov_b32 s76, s38
    s_mov_b32 s77, s39
    s_mov_b32 s78, 0x100
    s_mov_b32 s79, 0x20000
    v_mov_b32 v7, 0
    s_mov_b32 s44, 0
.LadaLN__nl_38:
    buffer_load_dword v127, v7, s[76:79], 0 offen sc1
    s_waitcnt vmcnt(0)
    v_readfirstlane_b32 s3, v127
    s_add_u32 s44, s44, 1
    s_cmp_ge_u32 s44, 0x40000
    s_cbranch_scc1 .LadaLN__no_39
    s_cmp_eq_u32 s3, 0
    s_cbranch_scc1 .LadaLN__nl_38
.LadaLN__no_39:
    s_add_u32 s76, s40, 0x1d10000
    s_addc_u32 s77, s41, 0
    s_mov_b32 s78, 0x4000
    s_mov_b32 s79, 0x20000
    v_and_b32 v7, 63, v0
    v_lshlrev_b32 v7, 6, v7
    v_and_b32 v10, 63, v0
    v_min_u32 v10, 5, v10
    v_and_b32 v8, 1, v10
    v_lshrrev_b32 v10, 1, v10
    v_lshlrev_b32 v10, 3, v10
    v_add_u32 v10, s63, v10
    v_lshl_add_u32 v10, v10, 1, v8
    v_add_u32 v10, 128, v10
    v_lshlrev_b32 v10, 6, v10
    s_mov_b32 s44, 0
    s_movk_i32 s45, 4096
.LadaLN__ap_36:
    buffer_load_dword v8, v7, s[76:79], 0 offen sc1
    buffer_load_dword v9, v7, s[76:79], s45 offen sc1
    buffer_load_dword v11, v10, s[76:79], 0 offen sc1
    s_waitcnt vmcnt(0)
    v_cmp_ne_u32 vcc, s3, v8
    v_cmp_ne_u32 s[80:81], s3, v9
    s_nop 0
    s_or_b64 vcc, vcc, s[80:81]
    v_cmp_ne_u32 s[80:81], s3, v11
    s_nop 0
    s_or_b64 vcc, vcc, s[80:81]
    s_add_u32 s44, s44, 1
    s_cmp_ge_u32 s44, 0x40000
    s_cbranch_scc1 .LadaLN__ao_37
    s_cbranch_vccnz .LadaLN__ap_36
.LadaLN__ao_37:
.LadaLN__aw_35:
    s_waitcnt lgkmcnt(0)
    s_barrier
    s_lshl_b32 s45, s2, 6
    s_add_u32 s62, s45, 264192
    buffer_load_dwordx4 v[32:35], v61, s[52:55], s45 offen sc1
    buffer_load_dwordx4 v[36:39], v61, s[52:55], s62 offen sc1
    v_add_u32 v5, 6144, v65
    buffer_load_dword v16, v65, s[64:67], 0 offen sc1
    buffer_load_dword v17, v65, s[64:67], 0 offen offset:2048 sc1
    buffer_load_dword v18, v5, s[64:67], 0 offen sc1
    buffer_load_dword v19, v5, s[64:67], 0 offen offset:2048 sc1
    v_add_u32 v66, 4096, v66
    v_add_u32 v5, 6144, v66
    buffer_load_dword v68, v66, s[64:67], 0 offen sc1
    buffer_load_dword v69, v5, s[64:67], 0 offen sc1
    buffer_load_dwordx4 v[48:51], v61, s[56:59], s45 offen sc1
    buffer_load_dwordx4 v[52:55], v61, s[56:59], s62 offen sc1
    s_waitcnt vmcnt(4)
    v_add_f32 v16, v16, v18
    v_add_f32 v17, v17, v19
    v_cvt_pk_bf16_f32 v16, v16, v17
    v_lshlrev_b32 v40, 16, v16
    v_and_b32 v42, 0xffff0000, v16
    v_add_f32 v42, 1.0, v42
    v_cvt_pk_bf16_f32 v42, v42, v42
    v_lshlrev_b32 v42, 16, v42
    v_lshlrev_b32 v72, 16, v32
    v_and_b32 v73, 0xffff0000, v32
    v_lshlrev_b32 v74, 16, v33
    v_and_b32 v75, 0xffff0000, v33
    v_lshlrev_b32 v76, 16, v34
    v_and_b32 v77, 0xffff0000, v34
    v_lshlrev_b32 v78, 16, v35
    v_and_b32 v79, 0xffff0000, v35
    v_pk_fma_f32 v[72:73], v[72:73], v[42:43], v[40:41] op_sel_hi:[1,0,0]
    v_pk_fma_f32 v[74:75], v[74:75], v[42:43], v[40:41] op_sel_hi:[1,0,0]
    v_pk_fma_f32 v[76:77], v[76:77], v[42:43], v[40:41] op_sel_hi:[1,0,0]
    v_pk_fma_f32 v[78:79], v[78:79], v[42:43], v[40:41] op_sel_hi:[1,0,0]
    v_cvt_pk_bf16_f32 v88, v72, v73
    v_cvt_pk_bf16_f32 v89, v74, v75
    v_cvt_pk_bf16_f32 v90, v76, v77
    v_cvt_pk_bf16_f32 v91, v78, v79
    ds_write_b128 v57, v[88:91] offset:480
    v_lshlrev_b32 v72, 16, v36
    v_and_b32 v73, 0xffff0000, v36
    v_lshlrev_b32 v74, 16, v37
    v_and_b32 v75, 0xffff0000, v37
    v_lshlrev_b32 v76, 16, v38
    v_and_b32 v77, 0xffff0000, v38
    v_lshlrev_b32 v78, 16, v39
    v_and_b32 v79, 0xffff0000, v39
    v_pk_fma_f32 v[72:73], v[72:73], v[42:43], v[40:41] op_sel_hi:[1,0,0]
    v_pk_fma_f32 v[74:75], v[74:75], v[42:43], v[40:41] op_sel_hi:[1,0,0]
    v_pk_fma_f32 v[76:77], v[76:77], v[42:43], v[40:41] op_sel_hi:[1,0,0]
    v_pk_fma_f32 v[78:79], v[78:79], v[42:43], v[40:41] op_sel_hi:[1,0,0]
    v_cvt_pk_bf16_f32 v92, v72, v73
    v_cvt_pk_bf16_f32 v93, v74, v75
    v_cvt_pk_bf16_f32 v94, v76, v77
    v_cvt_pk_bf16_f32 v95, v78, v79
    ds_write_b128 v57, v[92:95] offset:992
    s_waitcnt lgkmcnt(0)
    s_barrier
    ds_read_b64 v[8:9], v58 offset:3968
    ds_read_b64 v[10:11], v58 offset:3976
    ds_read_b128 a[12:15], v59 offset:384
    ds_read_b128 a[28:31], v59 offset:896
    ds_read_b128 a[44:47], v59 offset:1408
    ds_read_b128 a[60:63], v59 offset:1920
    ds_read_b128 a[76:79], v59 offset:2432
    ds_read_b128 a[92:95], v59 offset:2944
    ds_read_b128 a[108:111], v59 offset:3456
    ds_read_b128 a[124:127], v59 offset:3968
    ds_read_b64 v[12:13], v58 offset:3840
    ds_read_b64 v[14:15], v58 offset:3848
    ds_read_b64 v[16:17], v58 offset:3712
    ds_read_b64 v[18:19], v58 offset:3720
    ds_read_b128 a[8:11], v59 offset:256
    s_waitcnt lgkmcnt(12)
    v_mfma_f32_16x16x32_bf16 v[96:99], v[8:11], a[12:15], 0
    ds_read_b128 a[24:27], v59 offset:768
    s_waitcnt lgkmcnt(12)
    v_mfma_f32_16x16x32_bf16 v[100:103], v[8:11], a[28:31], 0
    ds_read_b128 a[40:43], v59 offset:1280
    s_waitcnt lgkmcnt(12)
    v_mfma_f32_16x16x32_bf16 v[104:107], v[8:11], a[44:47], 0
    ds_read_b128 a[56:59], v59 offset:1792
    s_waitcnt lgkmcnt(12)
    v_mfma_f32_16x16x32_bf16 v[108:111], v[8:11], a[60:63], 0
    ds_read_b128 a[72:75], v59 offset:2304
    s_waitcnt lgkmcnt(12)
    v_mfma_f32_16x16x32_bf16 v[112:115], v[8:11], a[76:79], 0
    ds_read_b128 a[88:91], v59 offset:2816
    s_waitcnt lgkmcnt(12)
    v_mfma_f32_16x16x32_bf16 v[116:119], v[8:11], a[92:95], 0
    ds_read_b128 a[104:107], v59 offset:3328
    s_waitcnt lgkmcnt(12)
    v_mfma_f32_16x16x32_bf16 v[120:123], v[8:11], a[108:111], 0
    ds_read_b128 a[120:123], v59 offset:3840
    s_waitcnt lgkmcnt(12)
    v_mfma_f32_16x16x32_bf16 v[124:127], v[8:11], a[124:127], 0
    ds_read_b64 v[20:21], v58 offset:3584
    ds_read_b64 v[22:23], v58 offset:3592
    ds_read_b128 a[4:7], v59 offset:128
    s_waitcnt lgkmcnt(10)
    v_mfma_f32_16x16x32_bf16 v[96:99], v[12:15], a[8:11], v[96:99]
    ds_read_b128 a[20:23], v59 offset:640
    s_waitcnt lgkmcnt(10)
    v_mfma_f32_16x16x32_bf16 v[100:103], v[12:15], a[24:27], v[100:103]
    ds_read_b128 a[36:39], v59 offset:1152
    s_waitcnt lgkmcnt(10)
    v_mfma_f32_16x16x32_bf16 v[104:107], v[12:15], a[40:43], v[104:107]
    ds_read_b128 a[52:55], v59 offset:1664
    s_waitcnt lgkmcnt(10)
    v_mfma_f32_16x16x32_bf16 v[108:111], v[12:15], a[56:59], v[108:111]
    ds_read_b128 a[68:71], v59 offset:2176
    s_waitcnt lgkmcnt(10)
    v_mfma_f32_16x16x32_bf16 v[112:115], v[12:15], a[72:75], v[112:115]
    ds_read_b128 a[84:87], v59 offset:2688
    s_waitcnt lgkmcnt(10)
    v_mfma_f32_16x16x32_bf16 v[116:119], v[12:15], a[88:91], v[116:119]
    ds_read_b128 a[100:103], v59 offset:3200
    s_waitcnt lgkmcnt(10)
    v_mfma_f32_16x16x32_bf16 v[120:123], v[12:15], a[104:107], v[120:123]
    ds_read_b128 a[116:119], v59 offset:3712
    s_waitcnt lgkmcnt(10)
    v_mfma_f32_16x16x32_bf16 v[124:127], v[12:15], a[120:123], v[124:127]
    ds_read_b64 v[8:9], v58 offset:3456
    ds_read_b64 v[10:11], v58 offset:3464
    ds_read_b128 a[0:3], v59 offset:0
    s_waitcnt lgkmcnt(10)
    v_mfma_f32_16x16x32_bf16 v[96:99], v[16:19], a[4:7], v[96:99]
    ds_read_b128 a[16:19], v59 offset:512
    s_waitcnt lgkmcnt(10)
    v_mfma_f32_16x16x32_bf16 v[100:103], v[16:19], a[20:23], v[100:103]
    ds_read_b128 a[32:35], v59 offset:1024
    s_waitcnt lgkmcnt(10)
    v_mfma_f32_16x16x32_bf16 v[104:107], v[16:19], a[36:39], v[104:107]
    ds_read_b128 a[48:51], v59 offset:1536
    s_waitcnt lgkmcnt(10)
    v_mfma_f32_16x16x32_bf16 v[108:111], v[16:19], a[52:55], v[108:111]
    ds_read_b128 a[64:67], v59 offset:2048
    s_waitcnt lgkmcnt(10)
    v_mfma_f32_16x16x32_bf16 v[112:115], v[16:19], a[68:71], v[112:115]
    ds_read_b128 a[80:83], v59 offset:2560
    s_waitcnt lgkmcnt(10)
    v_mfma_f32_16x16x32_bf16 v[116:119], v[16:19], a[84:87], v[116:119]
    ds_read_b128 a[96:99], v59 offset:3072
    s_waitcnt lgkmcnt(10)
    v_mfma_f32_16x16x32_bf16 v[120:123], v[16:19], a[100:103], v[120:123]
    ds_read_b128 a[112:115], v59 offset:3584
    s_waitcnt lgkmcnt(10)
    v_mfma_f32_16x16x32_bf16 v[124:127], v[16:19], a[116:119], v[124:127]
    ds_read_b64 v[12:13], v58 offset:3328
    ds_read_b64 v[14:15], v58 offset:3336
    s_waitcnt lgkmcnt(9)
    v_mfma_f32_16x16x32_bf16 v[96:99], v[20:23], a[0:3], v[96:99]
    s_waitcnt lgkmcnt(8)
    v_mfma_f32_16x16x32_bf16 v[100:103], v[20:23], a[16:19], v[100:103]
    s_waitcnt lgkmcnt(7)
    v_mfma_f32_16x16x32_bf16 v[104:107], v[20:23], a[32:35], v[104:107]
    s_waitcnt lgkmcnt(6)
    v_mfma_f32_16x16x32_bf16 v[108:111], v[20:23], a[48:51], v[108:111]
    s_waitcnt lgkmcnt(5)
    v_mfma_f32_16x16x32_bf16 v[112:115], v[20:23], a[64:67], v[112:115]
    s_waitcnt lgkmcnt(4)
    v_mfma_f32_16x16x32_bf16 v[116:119], v[20:23], a[80:83], v[116:119]
    s_waitcnt lgkmcnt(3)
    v_mfma_f32_16x16x32_bf16 v[120:123], v[20:23], a[96:99], v[120:123]
    s_waitcnt lgkmcnt(2)
    v_mfma_f32_16x16x32_bf16 v[124:127], v[20:23], a[112:115], v[124:127]
    ds_read_b64 v[16:17], v58 offset:3200
    ds_read_b64 v[18:19], v58 offset:3208
    v_mfma_f32_16x16x32_bf16 v[100:103], v[8:11], a[12:15], v[100:103]
    v_mfma_f32_16x16x32_bf16 v[104:107], v[8:11], a[28:31], v[104:107]
    v_mfma_f32_16x16x32_bf16 v[108:111], v[8:11], a[44:47], v[108:111]
    v_mfma_f32_16x16x32_bf16 v[112:115], v[8:11], a[60:63], v[112:115]
    v_mfma_f32_16x16x32_bf16 v[116:119], v[8:11], a[76:79], v[116:119]
    v_mfma_f32_16x16x32_bf16 v[120:123], v[8:11], a[92:95], v[120:123]
    v_mfma_f32_16x16x32_bf16 v[124:127], v[8:11], a[108:111], v[124:127]
    ds_read_b64 v[20:21], v58 offset:3072
    ds_read_b64 v[22:23], v58 offset:3080
    s_waitcnt lgkmcnt(4)
    v_mfma_f32_16x16x32_bf16 v[100:103], v[12:15], a[8:11], v[100:103]
    v_mfma_f32_16x16x32_bf16 v[104:107], v[12:15], a[24:27], v[104:107]
    v_mfma_f32_16x16x32_bf16 v[108:111], v[12:15], a[40:43], v[108:111]
    v_mfma_f32_16x16x32_bf16 v[112:115], v[12:15], a[56:59], v[112:115]
    v_mfma_f32_16x16x32_bf16 v[116:119], v[12:15], a[72:75], v[116:119]
    v_mfma_f32_16x16x32_bf16 v[120:123], v[12:15], a[88:91], v[120:123]
    v_mfma_f32_16x16x32_bf16 v[124:127], v[12:15], a[104:107], v[124:127]
    ds_read_b64 v[8:9], v58 offset:2944
    ds_read_b64 v[10:11], v58 offset:2952
    s_waitcnt lgkmcnt(4)
    v_mfma_f32_16x16x32_bf16 v[100:103], v[16:19], a[4:7], v[100:103]
    v_mfma_f32_16x16x32_bf16 v[104:107], v[16:19], a[20:23], v[104:107]
    v_mfma_f32_16x16x32_bf16 v[108:111], v[16:19], a[36:39], v[108:111]
    v_mfma_f32_16x16x32_bf16 v[112:115], v[16:19], a[52:55], v[112:115]
    v_mfma_f32_16x16x32_bf16 v[116:119], v[16:19], a[68:71], v[116:119]
    v_mfma_f32_16x16x32_bf16 v[120:123], v[16:19], a[84:87], v[120:123]
    v_mfma_f32_16x16x32_bf16 v[124:127], v[16:19], a[100:103], v[124:127]
    ds_read_b64 v[12:13], v58 offset:2816
    ds_read_b64 v[14:15], v58 offset:2824
    s_waitcnt lgkmcnt(4)
    v_mfma_f32_16x16x32_bf16 v[100:103], v[20:23], a[0:3], v[100:103]
    v_mfma_f32_16x16x32_bf16 v[104:107], v[20:23], a[16:19], v[104:107]
    v_mfma_f32_16x16x32_bf16 v[108:111], v[20:23], a[32:35], v[108:111]
    v_mfma_f32_16x16x32_bf16 v[112:115], v[20:23], a[48:51], v[112:115]
    v_mfma_f32_16x16x32_bf16 v[116:119], v[20:23], a[64:67], v[116:119]
    v_mfma_f32_16x16x32_bf16 v[120:123], v[20:23], a[80:83], v[120:123]
    v_mfma_f32_16x16x32_bf16 v[124:127], v[20:23], a[96:99], v[124:127]
    ds_read_b64 v[16:17], v58 offset:2688
    ds_read_b64 v[18:19], v58 offset:2696
    s_waitcnt lgkmcnt(4)
    v_mfma_f32_16x16x32_bf16 v[104:107], v[8:11], a[12:15], v[104:107]
    v_mfma_f32_16x16x32_bf16 v[108:111], v[8:11], a[28:31], v[108:111]
    v_mfma_f32_16x16x32_bf16 v[112:115], v[8:11], a[44:47], v[112:115]
    v_mfma_f32_16x16x32_bf16 v[116:119], v[8:11], a[60:63], v[116:119]
    v_mfma_f32_16x16x32_bf16 v[120:123], v[8:11], a[76:79], v[120:123]
    v_mfma_f32_16x16x32_bf16 v[124:127], v[8:11], a[92:95], v[124:127]
    ds_read_b64 v[20:21], v58 offset:2560
    ds_read_b64 v[22:23], v58 offset:2568
    s_waitcnt lgkmcnt(4)
    v_mfma_f32_16x16x32_bf16 v[104:107], v[12:15], a[8:11], v[104:107]
    v_mfma_f32_16x16x32_bf16 v[108:111], v[12:15], a[24:27], v[108:111]
    v_mfma_f32_16x16x32_bf16 v[112:115], v[12:15], a[40:43], v[112:115]
    v_mfma_f32_16x16x32_bf16 v[116:119], v[12:15], a[56:59], v[116:119]
    v_mfma_f32_16x16x32_bf16 v[120:123], v[12:15], a[72:75], v[120:123]
    v_mfma_f32_16x16x32_bf16 v[124:127], v[12:15], a[88:91], v[124:127]
    ds_read_b64 v[8:9], v58 offset:2432
    ds_read_b64 v[10:11], v58 offset:2440
    s_waitcnt lgkmcnt(4)
    v_mfma_f32_16x16x32_bf16 v[104:107], v[16:19], a[4:7], v[104:107]
    v_mfma_f32_16x16x32_bf16 v[108:111], v[16:19], a[20:23], v[108:111]
    v_mfma_f32_16x16x32_bf16 v[112:115], v[16:19], a[36:39], v[112:115]
    v_mfma_f32_16x16x32_bf16 v[116:119], v[16:19], a[52:55], v[116:119]
    v_mfma_f32_16x16x32_bf16 v[120:123], v[16:19], a[68:71], v[120:123]
    v_mfma_f32_16x16x32_bf16 v[124:127], v[16:19], a[84:87], v[124:127]
    ds_read_b64 v[12:13], v58 offset:2304
    ds_read_b64 v[14:15], v58 offset:2312
    s_waitcnt lgkmcnt(4)
    v_mfma_f32_16x16x32_bf16 v[104:107], v[20:23], a[0:3], v[104:107]
    v_mfma_f32_16x16x32_bf16 v[108:111], v[20:23], a[16:19], v[108:111]
    v_mfma_f32_16x16x32_bf16 v[112:115], v[20:23], a[32:35], v[112:115]
    v_mfma_f32_16x16x32_bf16 v[116:119], v[20:23], a[48:51], v[116:119]
    v_mfma_f32_16x16x32_bf16 v[120:123], v[20:23], a[64:67], v[120:123]
    v_mfma_f32_16x16x32_bf16 v[124:127], v[20:23], a[80:83], v[124:127]
    ds_read_b64 v[16:17], v58 offset:2176
    ds_read_b64 v[18:19], v58 offset:2184
    s_waitcnt lgkmcnt(4)
    v_mfma_f32_16x16x32_bf16 v[108:111], v[8:11], a[12:15], v[108:111]
    v_mfma_f32_16x16x32_bf16 v[112:115], v[8:11], a[28:31], v[112:115]
    v_mfma_f32_16x16x32_bf16 v[116:119], v[8:11], a[44:47], v[116:119]
    v_mfma_f32_16x16x32_bf16 v[120:123], v[8:11], a[60:63], v[120:123]
    v_mfma_f32_16x16x32_bf16 v[124:127], v[8:11], a[76:79], v[124:127]
    ds_read_b64 v[20:21], v58 offset:2048
    ds_read_b64 v[22:23], v58 offset:2056
    s_waitcnt lgkmcnt(4)
    v_mfma_f32_16x16x32_bf16 v[108:111], v[12:15], a[8:11], v[108:111]
    v_mfma_f32_16x16x32_bf16 v[112:115], v[12:15], a[24:27], v[112:115]
    v_mfma_f32_16x16x32_bf16 v[116:119], v[12:15], a[40:43], v[116:119]
    v_mfma_f32_16x16x32_bf16 v[120:123], v[12:15], a[56:59], v[120:123]
    v_mfma_f32_16x16x32_bf16 v[124:127], v[12:15], a[72:75], v[124:127]
    ds_read_b64 v[8:9], v58 offset:1920
    ds_read_b64 v[10:11], v58 offset:1928
    s_waitcnt lgkmcnt(4)
    v_mfma_f32_16x16x32_bf16 v[108:111], v[16:19], a[4:7], v[108:111]
    v_mfma_f32_16x16x32_bf16 v[112:115], v[16:19], a[20:23], v[112:115]
    v_mfma_f32_16x16x32_bf16 v[116:119], v[16:19], a[36:39], v[116:119]
    v_mfma_f32_16x16x32_bf16 v[120:123], v[16:19], a[52:55], v[120:123]
    v_mfma_f32_16x16x32_bf16 v[124:127], v[16:19], a[68:71], v[124:127]
    ds_read_b64 v[12:13], v58 offset:1792
    ds_read_b64 v[14:15], v58 offset:1800
    s_waitcnt lgkmcnt(4)
    v_mfma_f32_16x16x32_bf16 v[108:111], v[20:23], a[0:3], v[108:111]
    v_mfma_f32_16x16x32_bf16 v[112:115], v[20:23], a[16:19], v[112:115]
    v_mfma_f32_16x16x32_bf16 v[116:119], v[20:23], a[32:35], v[116:119]
    v_mfma_f32_16x16x32_bf16 v[120:123], v[20:23], a[48:51], v[120:123]
    v_mfma_f32_16x16x32_bf16 v[124:127], v[20:23], a[64:67], v[124:127]
    ds_read_b64 v[16:17], v58 offset:1664
    ds_read_b64 v[18:19], v58 offset:1672
    s_waitcnt lgkmcnt(4)
    v_mfma_f32_16x16x32_bf16 v[112:115], v[8:11], a[12:15], v[112:115]
    v_mfma_f32_16x16x32_bf16 v[116:119], v[8:11], a[28:31], v[116:119]
    v_mfma_f32_16x16x32_bf16 v[120:123], v[8:11], a[44:47], v[120:123]
    v_mfma_f32_16x16x32_bf16 v[124:127], v[8:11], a[60:63], v[124:127]
    ds_read_b64 v[20:21], v58 offset:1536
    ds_read_b64 v[22:23], v58 offset:1544
    s_waitcnt lgkmcnt(4)
    v_mfma_f32_16x16x32_bf16 v[112:115], v[12:15], a[8:11], v[112:115]
    v_mfma_f32_16x16x32_bf16 v[116:119], v[12:15], a[24:27], v[116:119]
    v_mfma_f32_16x16x32_bf16 v[120:123], v[12:15], a[40:43], v[120:123]
    v_mfma_f32_16x16x32_bf16 v[124:127], v[12:15], a[56:59], v[124:127]
    ds_read_b64 v[8:9], v58 offset:1408
    ds_read_b64 v[10:11], v58 offset:1416
    s_waitcnt lgkmcnt(4)
    v_mfma_f32_16x16x32_bf16 v[112:115], v[16:19], a[4:7], v[112:115]
    v_mfma_f32_16x16x32_bf16 v[116:119], v[16:19], a[20:23], v[116:119]
    v_mfma_f32_16x16x32_bf16 v[120:123], v[16:19], a[36:39], v[120:123]
    v_mfma_f32_16x16x32_bf16 v[124:127], v[16:19], a[52:55], v[124:127]
    ds_read_b64 v[12:13], v58 offset:1280
    ds_read_b64 v[14:15], v58 offset:1288
    s_waitcnt lgkmcnt(4)
    v_mfma_f32_16x16x32_bf16 v[112:115], v[20:23], a[0:3], v[112:115]
    v_mfma_f32_16x16x32_bf16 v[116:119], v[20:23], a[16:19], v[116:119]
    v_mfma_f32_16x16x32_bf16 v[120:123], v[20:23], a[32:35], v[120:123]
    v_mfma_f32_16x16x32_bf16 v[124:127], v[20:23], a[48:51], v[124:127]
    ds_read_b64 v[16:17], v58 offset:1152
    ds_read_b64 v[18:19], v58 offset:1160
    s_waitcnt lgkmcnt(4)
    v_mfma_f32_16x16x32_bf16 v[116:119], v[8:11], a[12:15], v[116:119]
    v_mfma_f32_16x16x32_bf16 v[120:123], v[8:11], a[28:31], v[120:123]
    v_mfma_f32_16x16x32_bf16 v[124:127], v[8:11], a[44:47], v[124:127]
    ds_read_b64 v[20:21], v58 offset:1024
    ds_read_b64 v[22:23], v58 offset:1032
    s_waitcnt lgkmcnt(4)
    v_mfma_f32_16x16x32_bf16 v[116:119], v[12:15], a[8:11], v[116:119]
    v_mfma_f32_16x16x32_bf16 v[120:123], v[12:15], a[24:27], v[120:123]
    v_mfma_f32_16x16x32_bf16 v[124:127], v[12:15], a[40:43], v[124:127]
    ds_read_b64 v[8:9], v58 offset:896
    ds_read_b64 v[10:11], v58 offset:904
    s_waitcnt lgkmcnt(4)
    v_mfma_f32_16x16x32_bf16 v[116:119], v[16:19], a[4:7], v[116:119]
    v_mfma_f32_16x16x32_bf16 v[120:123], v[16:19], a[20:23], v[120:123]
    v_mfma_f32_16x16x32_bf16 v[124:127], v[16:19], a[36:39], v[124:127]
    ds_read_b64 v[12:13], v58 offset:768
    ds_read_b64 v[14:15], v58 offset:776
    s_waitcnt lgkmcnt(4)
    v_mfma_f32_16x16x32_bf16 v[116:119], v[20:23], a[0:3], v[116:119]
    v_mfma_f32_16x16x32_bf16 v[120:123], v[20:23], a[16:19], v[120:123]
    v_mfma_f32_16x16x32_bf16 v[124:127], v[20:23], a[32:35], v[124:127]
    ds_read_b64 v[16:17], v58 offset:640
    ds_read_b64 v[18:19], v58 offset:648
    s_waitcnt lgkmcnt(4)
    v_mfma_f32_16x16x32_bf16 v[120:123], v[8:11], a[12:15], v[120:123]
    v_mfma_f32_16x16x32_bf16 v[124:127], v[8:11], a[28:31], v[124:127]
    ds_read_b64 v[20:21], v58 offset:512
    ds_read_b64 v[22:23], v58 offset:520
    s_waitcnt lgkmcnt(4)
    v_mfma_f32_16x16x32_bf16 v[120:123], v[12:15], a[8:11], v[120:123]
    v_mfma_f32_16x16x32_bf16 v[124:127], v[12:15], a[24:27], v[124:127]
    ds_read_b64 v[8:9], v58 offset:384
    ds_read_b64 v[10:11], v58 offset:392
    s_waitcnt lgkmcnt(4)
    v_mfma_f32_16x16x32_bf16 v[120:123], v[16:19], a[4:7], v[120:123]
    v_mfma_f32_16x16x32_bf16 v[124:127], v[16:19], a[20:23], v[124:127]
    ds_read_b64 v[12:13], v58 offset:256
    ds_read_b64 v[14:15], v58 offset:264
    s_waitcnt lgkmcnt(4)
    v_mfma_f32_16x16x32_bf16 v[120:123], v[20:23], a[0:3], v[120:123]
    v_mfma_f32_16x16x32_bf16 v[124:127], v[20:23], a[16:19], v[124:127]
    ds_read_b64 v[16:17], v58 offset:128
    ds_read_b64 v[18:19], v58 offset:136
    s_waitcnt lgkmcnt(4)
    v_mfma_f32_16x16x32_bf16 v[124:127], v[8:11], a[12:15], v[124:127]
    ds_read_b64 v[20:21], v58 offset:0
    ds_read_b64 v[22:23], v58 offset:8
    s_waitcnt lgkmcnt(4)
    v_mfma_f32_16x16x32_bf16 v[124:127], v[12:15], a[8:11], v[124:127]
    s_waitcnt lgkmcnt(2)
    v_mfma_f32_16x16x32_bf16 v[124:127], v[16:19], a[4:7], v[124:127]
    s_waitcnt lgkmcnt(0)
    v_mfma_f32_16x16x32_bf16 v[124:127], v[20:23], a[0:3], v[124:127]
    s_waitcnt vmcnt(0)
    v_add_f32 v68, v68, v69
    v_cvt_pk_bf16_f32 v68, v68, v68
    v_lshlrev_b32 v44, 16, v68
    ds_write_b128 v63, v[48:51] offset:0
    ds_write_b128 v63, v[52:55] offset:512
    s_lshl_b32 s44, s42, 12
    s_add_u32 s44, s44, 42496
    v_lshl_add_u32 v4, v2, 4, s44
    s_cmp_eq_u32 s47, 0
    s_cbranch_scc0 .LadaLN__p1_40
    ds_write_b128 v4, v[112:115] offset:0
    ds_write_b128 v4, v[116:119] offset:1024
    ds_write_b128 v4, v[120:123] offset:2048
    ds_write_b128 v4, v[124:127] offset:3072
    s_branch .LadaLN__pj_41
.LadaLN__p1_40:
    s_nop 7
    ds_write_b128 v4, v[96:99] offset:0
    ds_write_b128 v4, v[100:103] offset:1024
    ds_write_b128 v4, v[104:107] offset:2048
    ds_write_b128 v4, v[108:111] offset:3072
    s_nop 1
    v_mov_b32 v96, v112
    v_mov_b32 v97, v113
    v_mov_b32 v98, v114
    v_mov_b32 v99, v115
    v_mov_b32 v100, v116
    v_mov_b32 v101, v117
    v_mov_b32 v102, v118
    v_mov_b32 v103, v119
    v_mov_b32 v104, v120
    v_mov_b32 v105, v121
    v_mov_b32 v106, v122
    v_mov_b32 v107, v123
    v_mov_b32 v108, v124
    v_mov_b32 v109, v125
    v_mov_b32 v110, v126
    v_mov_b32 v111, v127
.LadaLN__pj_41:
    s_waitcnt lgkmcnt(0)
    s_barrier
    s_xor_b32 s44, s42, 1
    s_lshl_b32 s44, s44, 12
    s_add_u32 s44, s44, 42496
    v_lshl_add_u32 v4, v2, 4, s44
    ds_read_b128 v[8:11], v4 offset:0
    ds_read_b128 v[12:15], v4 offset:1024
    ds_read_b128 v[16:19], v4 offset:2048
    ds_read_b128 v[20:23], v4 offset:3072
    ds_read_b64 v[24:25], v60 offset:480
    ds_read_b64 v[26:27], v60 offset:992
    ds_read_b64 v[28:29], v60 offset:1504
    ds_read_b64 v[30:31], v60 offset:2016
    ds_read_b64 v[48:49], v67 offset:0
    ds_read_b64 v[50:51], v67 offset:512
    ds_read_b64 v[52:53], v67 offset:1024
    ds_read_b64 v[54:55], v67 offset:1536
    s_waitcnt vmcnt(10)
    v_lshlrev_b32 v46, 16, v46
    s_lshl_b32 s45, s46, 6
    s_waitcnt lgkmcnt(3)
    v_pk_add_f32 v[96:97], v[96:97], v[8:9]
    v_pk_add_f32 v[98:99], v[98:99], v[10:11]
    v_lshlrev_b32 v72, 16, v24
    v_and_b32 v73, 0xffff0000, v24
    v_lshlrev_b32 v76, 16, v48
    v_and_b32 v77, 0xffff0000, v48
    v_lshlrev_b32 v74, 16, v25
    v_and_b32 v75, 0xffff0000, v25
    v_lshlrev_b32 v78, 16, v49
    v_and_b32 v79, 0xffff0000, v49
    v_pk_fma_f32 v[96:97], v[72:73], v[46:47], v[96:97] op_sel_hi:[1,0,1]
    v_pk_fma_f32 v[98:99], v[74:75], v[46:47], v[98:99] op_sel_hi:[1,0,1]
    v_pk_fma_f32 v[96:97], v[96:97], v[44:45], v[76:77] op_sel_hi:[1,0,1]
    v_pk_fma_f32 v[98:99], v[98:99], v[44:45], v[78:79] op_sel_hi:[1,0,1]
    v_cvt_pk_bf16_f32 v88, v96, v97
    v_cvt_pk_bf16_f32 v89, v98, v99
    buffer_store_dwordx2 v[88:89], v62, s[72:75], s45 offen
    s_add_u32 s45, s45, 264192
    s_waitcnt lgkmcnt(2)
    v_pk_add_f32 v[100:101], v[100:101], v[12:13]
    v_pk_add_f32 v[102:103], v[102:103], v[14:15]
    v_lshlrev_b32 v72, 16, v26
    v_and_b32 v73, 0xffff0000, v26
    v_lshlrev_b32 v76, 16, v50
    v_and_b32 v77, 0xffff0000, v50
    v_lshlrev_b32 v74, 16, v27
    v_and_b32 v75, 0xffff0000, v27
    v_lshlrev_b32 v78, 16, v51
    v_and_b32 v79, 0xffff0000, v51
    v_pk_fma_f32 v[100:101], v[72:73], v[46:47], v[100:101] op_sel_hi:[1,0,1]
    v_pk_fma_f32 v[102:103], v[74:75], v[46:47], v[102:103] op_sel_hi:[1,0,1]
    v_pk_fma_f32 v[100:101], v[100:101], v[44:45], v[76:77] op_sel_hi:[1,0,1]
    v_pk_fma_f32 v[102:103], v[102:103], v[44:45], v[78:79] op_sel_hi:[1,0,1]
    v_cvt_pk_bf16_f32 v90, v100, v101
    v_cvt_pk_bf16_f32 v91, v102, v103
    buffer_store_dwordx2 v[90:91], v62, s[72:75], s45 offen
    s_add_u32 s45, s45, 264192
    s_waitcnt lgkmcnt(1)
    v_pk_add_f32 v[104:105], v[104:105], v[16:17]
    v_pk_add_f32 v[106:107], v[106:107], v[18:19]
    v_lshlrev_b32 v72, 16, v28
    v_and_b32 v73, 0xffff0000, v28
    v_lshlrev_b32 v76, 16, v52
    v_and_b32 v77, 0xffff0000, v52
    v_lshlrev_b32 v74, 16, v29
    v_and_b32 v75, 0xffff0000, v29
    v_lshlrev_b32 v78, 16, v53
    v_and_b32 v79, 0xffff0000, v53
    v_pk_fma_f32 v[104:105], v[72:73], v[46:47], v[104:105] op_sel_hi:[1,0,1]
    v_pk_fma_f32 v[106:107], v[74:75], v[46:47], v[106:107] op_sel_hi:[1,0,1]
    v_pk_fma_f32 v[104:105], v[104:105], v[44:45], v[76:77] op_sel_hi:[1,0,1]
    v_pk_fma_f32 v[106:107], v[106:107], v[44:45], v[78:79] op_sel_hi:[1,0,1]
    v_cvt_pk_bf16_f32 v92, v104, v105
    v_cvt_pk_bf16_f32 v93, v106, v107
    buffer_store_dwordx2 v[92:93], v62, s[72:75], s45 offen
    s_add_u32 s45, s45, 264192
    s_waitcnt lgkmcnt(0)
    v_pk_add_f32 v[108:109], v[108:109], v[20:21]
    v_pk_add_f32 v[110:111], v[110:111], v[22:23]
    v_lshlrev_b32 v72, 16, v30
    v_and_b32 v73, 0xffff0000, v30
    v_lshlrev_b32 v76, 16, v54
    v_and_b32 v77, 0xffff0000, v54
    v_lshlrev_b32 v74, 16, v31
    v_and_b32 v75, 0xffff0000, v31
    v_lshlrev_b32 v78, 16, v55
    v_and_b32 v79, 0xffff0000, v55
    v_pk_fma_f32 v[108:109], v[72:73], v[46:47], v[108:109] op_sel_hi:[1,0,1]
    v_pk_fma_f32 v[110:111], v[74:75], v[46:47], v[110:111] op_sel_hi:[1,0,1]
    v_pk_fma_f32 v[108:109], v[108:109], v[44:45], v[76:77] op_sel_hi:[1,0,1]
    v_pk_fma_f32 v[110:111], v[110:111], v[44:45], v[78:79] op_sel_hi:[1,0,1]
    v_cvt_pk_bf16_f32 v94, v108, v109
    v_cvt_pk_bf16_f32 v95, v110, v111
    buffer_store_dwordx2 v[94:95], v62, s[72:75], s45 offen
    s_cmp_eq_u32 s42, 0
    s_cbranch_scc0 .LadaLN__pe_42
    s_getpc_b64 s[44:45]
.LadaLN__pch_43:
    s_add_u32 s44, s44, CODE_FROM-.LadaLN__pch_43
    s_addc_u32 s45, s45, 0
    s_lshr_b32 s46, s2, 3
    s_cmp_lt_u32 s46, (CODE_TO-CODE_FROM+8191)/8192
    s_cbranch_scc0 .LadaLN__pe_42
    s_lshl_b32 s46, s46, 13
    v_and_b32 v100, 63, v0
    v_lshlrev_b32 v101, 7, v100
    v_add_u32 v101, s46, v101
    v_min_u32 v101, CODE_TO-CODE_FROM-4, v101
    global_load_dword v104, v101, s[44:45]
.LadaLN__pe_42:
    s_endpgm
.LadaLN__N_6:
    s_cmp_eq_u32 s42, 0
    s_cbranch_scc0 .LadaLN__end_7
    s_add_u32 s48, s40, 0x1d14000
    s_addc_u32 s49, s41, 0
    s_mov_b32 s50, 0x40
    s_mov_b32 s51, 0x20000
    s_mov_b32 s52, s38
    s_mov_b32 s53, s39
    s_mov_b32 s54, 0x100
    s_mov_b32 s55, 0x20000
    v_mov_b32 v2, 0
    buffer_load_dword v3, v2, s[48:51], 0 offen sc1
    s_waitcnt vmcnt(0)
    v_add_u32 v3, 1, v3
    v_max_u32 v3, 1, v3
    v_and_b32 v4, 63, v0
    v_cmp_eq_u32 vcc, 0, v4
    v_mov_b32 v4, 0x7ff00000
    s_nop 0
    v_cndmask_b32 v4, v4, 0, vcc
    buffer_store_dword v3, v4, s[48:51], 0 offen sc1
    buffer_store_dword v3, v4, s[52:55], 0 offen sc1
    s_endpgm
.LadaLN__Z_5:
    s_add_u32 s48, s40, 0x1d00000
    s_addc_u32 s49, s41, 0
    s_mov_b32 s50, 0x10000
    s_mov_b32 s51, 0x20000
    s_sub_u32 s44, s2, 460
    s_lshl_b32 s44, s44, 12
    v_lshlrev_b32 v2, 4, v0
    v_mov_b32 v4, 0
    v_mov_b32 v5, 0
    v_mov_b32 v6, 0
    v_mov_b32 v7, 0
    buffer_store_dwordx4 v[4:7], v2, s[48:51], s44 offen
.LadaLN__end_7:
    s_endpgm
.p2align 8
CODE_FROM:
.globl mlp_kernel
.p2align 8
.type mlp_kernel,@function
mlp_kernel:
    s_cmp_ge_u32 s2, 256
    s_cbranch_scc1 .Lmlp_ke_end_1
    s_load_dwordx2 s[36:37], s[0:1], 128
    s_load_dwordx2 s[40:41], s[0:1], 144
    v_lshrrev_b32 v1, 6, v0
    s_nop 0
    v_readfirstlane_b32 s42, v1
    s_and_b32 s90, s2, 7
    s_lshl_b32 s90, s90, 2
    s_lshr_b32 s91, s2, 6
    s_add_u32 s90, s90, s91
    s_lshr_b32 s91, s2, 3
    s_and_b32 s91, s91, 7
    s_lshr_b32 s93, s91, 2
    s_lshl_b32 s92, s90, 1
    s_add_u32 s92, s92, s93
    s_and_b32 s93, s91, 3
    s_lshl_b32 s94, s92, 5
    s_lshl_b32 s95, s90, 6
    s_lshl_b32 s25, s90, 3
    s_add_u32 s25, s25, s91
    s_mov_b32 s24, 1
    v_and_b32 v2, 63, v0
    v_and_b32 v3, 15, v2
    v_lshrrev_b32 v4, 4, v2
    v_lshlrev_b32 v5, 4, v2
    v_lshlrev_b32 v137, 7, v2
    s_waitcnt lgkmcnt(0)
    s_add_u32 s48, s40, 0x2400000
    s_addc_u32 s49, s41, 0
    s_mov_b32 s50, 0x204000
    s_mov_b32 s51, 0x20000
    v_lshrrev_b32 v6, 2, v2
    v_lshrrev_b32 v7, 4, v2
    v_and_b32 v7, 2, v7
    v_and_b32 v8, 3, v2
    v_xor_b32 v7, v7, v8
    v_lshlrev_b32 v6, 6, v6
    v_lshl_add_u32 v6, v7, 4, v6
    s_lshl_b32 s46, s42, 13
    s_mul_i32 s45, s92, 33024
    s_add_u32 s45, s45, s46
    s_add_u32 m0, s46, 0
    s_nop 0
    buffer_load_dwordx4 v6, s[48:51], s45 offen sc1 lds
    s_add_u32 m0, s46, 1024
    s_add_u32 s45, s45, 1024
    buffer_load_dwordx4 v6, s[48:51], s45 offen sc1 lds
    s_add_u32 m0, s46, 2048
    s_add_u32 s45, s45, 1024
    buffer_load_dwordx4 v6, s[48:51], s45 offen sc1 lds
    s_add_u32 m0, s46, 3072
    s_add_u32 s45, s45, 1024
    buffer_load_dwordx4 v6, s[48:51], s45 offen sc1 lds
    s_add_u32 m0, s46, 4096
    s_add_u32 s45, s45, 1024
    buffer_load_dwordx4 v6, s[48:51], s45 offen sc1 lds
    s_add_u32 m0, s46, 5120
    s_add_u32 s45, s45, 1024
    buffer_load_dwordx4 v6, s[48:51], s45 offen sc1 lds
    s_add_u32 m0, s46, 6144
    s_add_u32 s45, s45, 1024
    buffer_load_dwordx4 v6, s[48:51], s45 offen sc1 lds
    s_add_u32 m0, s46, 7168
    s_add_u32 s45, s45, 1024
    buffer_load_dwordx4 v6, s[48:51], s45 offen sc1 lds
    s_add_u32 s52, s40, 0x1c00000
    s_addc_u32 s53, s41, 0
    s_mov_b32 s54, 0x3000
    s_mov_b32 s55, 0x20000
    s_add_u32 s64, s40, 0x1c04000
    s_addc_u32 s65, s41, 0
    s_mov_b32 s66, 0x1000
    s_mov_b32 s67, 0x20000
    s_add_u32 s68, s40, 0x900000
    s_addc_u32 s69, s41, 0
    s_mov_b32 s70, 0x200000
    s_mov_b32 s71, 0x20000
    s_add_u32 s76, s40, 0xd00000
    s_addc_u32 s77, s41, 0
    s_mov_b32 s78, 0x200000
    s_mov_b32 s79, 0x20000
    s_and_b32 s47, s42, 1
    s_lshr_b32 s60, s42, 1
    s_lshl_b32 s44, s42, 10
    s_add_u32 m0, s44, 65536
    s_add_u32 s44, s44, 6144
    buffer_load_dwordx4 v5, s[52:55], s44 offen sc1 lds
    s_lshl_b32 s44, s93, 2
    s_add_u32 s44, s44, s42
    s_lshl_b32 s44, s44, 7
    v_lshlrev_b32 v6, 5, v4
    buffer_load_dwordx4 v[8:11], v6, s[64:67], s44 offen sc1
    buffer_load_dwordx4 v[12:15], v6, s[64:67], s44 offen offset:16 sc1
    buffer_load_dwordx4 v[16:19], v6, s[64:67], s44 offen offset:2048 sc1
    buffer_load_dwordx4 v[20:23], v6, s[64:67], s44 offen offset:2064 sc1
    s_cmp_eq_u32 s42, 3
    s_cbranch_scc0 .Lmlp_ke_sc_2
    s_getpc_b64 s[84:85]
.Lmlp_ke_sch_3:
    s_sub_u32 s84, s84, .Lmlp_ke_sch_3-CODE_FROM
    s_subb_u32 s85, s85, 0
    s_lshr_b32 s83, s2, 3
    s_cmp_lt_u32 s83, (CODE_TO-CODE_FROM+8191)/8192
    s_cbranch_scc0 .Lmlp_ke_sc_2
    s_lshl_b32 s83, s83, 13
    v_add_u32 v7, s83, v137
    v_min_u32 v7, CODE_TO-CODE_FROM-4, v7
    global_load_dword v0, v7, s[84:85]
.Lmlp_ke_sc_2:
    s_lshl_b32 s44, s93, 2
    s_add_u32 s44, s44, s42
    s_lshl_b32 s44, s44, 15
    s_add_u32 s4, s40, 0x1700000
    s_addc_u32 s5, s41, 0
    s_add_u32 s4, s4, s44
    s_addc_u32 s5, s5, 0
    s_sub_i32 s6, 0x80000, s44
    s_max_i32 s6, s6, 0
    s_mov_b32 s7, 0x20000
    s_add_u32 s8, s40, 0x1780000
    s_addc_u32 s9, s41, 0
    s_add_u32 s8, s8, s44
    s_addc_u32 s9, s9, 0
    s_sub_i32 s10, 0x80000, s44
    s_max_i32 s10, s10, 0
    s_mov_b32 s11, 0x20000
    s_lshl_b32 s44, s91, 2
    s_add_u32 s44, s44, s42
    s_mul_i32 s44, s44, 49152
    s_add_u32 s12, s40, 0x1800000
    s_addc_u32 s13, s41, 0
    s_add_u32 s12, s12, s44
    s_addc_u32 s13, s13, 0
    s_sub_i32 s14, 0x158000, s44
    s_max_i32 s14, s14, 0
    s_mov_b32 s15, 0x20000
    s_mul_i32 s44, s91, 176128
    s_mul_i32 s45, s42, 45056
    s_add_u32 s44, s44, s45
    s_add_u32 s16, s40, 0x1a00000
    s_addc_u32 s17, s41, 0
    s_add_u32 s16, s16, s44
    s_addc_u32 s17, s17, 0
    s_sub_i32 s18, 0x158000, s44
    s_max_i32 s18, s18, 0
    s_mov_b32 s19, 0x20000
    s_add_u32 s20, s40, 0x1d00000
    s_addc_u32 s21, s41, 0
    s_mov_b32 s22, 0x10000
    s_mov_b32 s23, 0x20000
    s_mov_b32 s26, 0
    buffer_load_dwordx4 a[0:3], v5, s[4:7], s26 offen offset:0
    buffer_load_dwordx4 a[4:7], v5, s[4:7], s26 offen offset:1024
    buffer_load_dwordx4 a[8:11], v5, s[4:7], s26 offen offset:2048
    buffer_load_dwordx4 a[12:15], v5, s[4:7], s26 offen offset:3072
    s_add_u32 s26, s26, 4096
    buffer_load_dwordx4 a[16:19], v5, s[4:7], s26 offen offset:0
    buffer_load_dwordx4 a[20:23], v5, s[4:7], s26 offen offset:1024
    buffer_load_dwordx4 a[24:27], v5, s[4:7], s26 offen offset:2048
    buffer_load_dwordx4 a[28:31], v5, s[4:7], s26 offen offset:3072
    s_add_u32 s26, s26, 4096
    buffer_load_dwordx4 a[32:35], v5, s[4:7], s26 offen offset:0
    buffer_load_dwordx4 a[36:39], v5, s[4:7], s26 offen offset:1024
    buffer_load_dwordx4 a[40:43], v5, s[4:7], s26 offen offset:2048
    buffer_load_dwordx4 a[44:47], v5, s[4:7], s26 offen offset:3072
    s_add_u32 s26, s26, 4096
    buffer_load_dwordx4 a[48:51], v5, s[4:7], s26 offen offset:0
    buffer_load_dwordx4 a[52:55], v5, s[4:7], s26 offen offset:1024
    buffer_load_dwordx4 a[56:59], v5, s[4:7], s26 offen offset:2048
    buffer_load_dwordx4 a[60:63], v5, s[4:7], s26 offen offset:3072
    v_bfe_u32 v6, v2, 2, 2
    v_lshl_add_u32 v6, v4, 3, v6
    v_lshlrev_b32 v24, 6, v6
    v_bfe_u32 v6, v2, 1, 1
    s_lshl_b32 s44, s47, 1
    v_add_u32 v6, s44, v6
    v_and_b32 v7, 1, v4
    v_lshlrev_b32 v7, 1, v7
    v_xor_b32 v6, v6, v7
    v_lshl_add_u32 v24, v6, 4, v24
    v_and_b32 v6, 1, v2
    v_lshl_add_u32 v24, v6, 3, v24
    s_lshl_b32 s44, s60, 14
    v_add_u32 v24, s44, v24
    s_lshl_b32 s44, s60, 10
    s_add_u32 s44, s44, 65536
    v_lshl_add_u32 v25, v4, 5, s44
    s_lshl_b32 s44, s60, 14
    s_lshl_b32 s45, s47, 8
    s_add_u32 s44, s44, s45
    s_add_u32 s44, s44, 32768
    v_lshlrev_b32 v26, 9, v4
    v_lshl_add_u32 v26, v3, 4, v26
    v_add_u32 v26, s44, v26
    v_lshlrev_b32 v28, 9, v4
    v_lshl_add_u32 v28, v3, 4, v28
    v_add_u32 v28, 32768, v28
    s_lshl_b32 s44, s42, 7
    s_add_u32 s44, s44, 69632
    v_lshl_add_u32 v27, v3, 3, s44
    v_mov_b32 v30, 0x3f803f80
    v_mov_b32 v96, 0
    v_mov_b32 v97, 0
    v_mov_b32 v98, 0
    v_mov_b32 v99, 0
    s_waitcnt vmcnt(20)
    s_barrier
    ds_read_b64_tr_b16 v[32:33], v24 offset:0
    ds_read_b64_tr_b16 v[34:35], v24 offset:256
    ds_read_b64_tr_b16 v[36:37], v24 offset:2048
    ds_read_b64_tr_b16 v[38:39], v24 offset:2304
    ds_read_b64_tr_b16 v[40:41], v24 offset:4096
    ds_read_b64_tr_b16 v[42:43], v24 offset:4352
    ds_read_b64_tr_b16 v[44:45], v24 offset:6144
    ds_read_b64_tr_b16 v[46:47], v24 offset:6400
    ds_read_b64_tr_b16 v[48:49], v24 offset:8192
    ds_read_b64_tr_b16 v[50:51], v24 offset:8448
    ds_read_b64_tr_b16 v[52:53], v24 offset:10240
    ds_read_b64_tr_b16 v[54:55], v24 offset:10496
    ds_read_b64_tr_b16 v[56:57], v24 offset:12288
    ds_read_b64_tr_b16 v[58:59], v24 offset:12544
    ds_read_b64_tr_b16 v[60:61], v24 offset:14336
    ds_read_b64_tr_b16 v[62:63], v24 offset:14592
    s_waitcnt lgkmcnt(14)
    v_dot2_f32_bf16 v96, v32, v30, v96
    v_dot2_f32_bf16 v98, v32, v32, v98
    v_dot2_f32_bf16 v97, v33, v30, v97
    v_dot2_f32_bf16 v99, v33, v33, v99
    v_dot2_f32_bf16 v96, v34, v30, v96
    v_dot2_f32_bf16 v98, v34, v34, v98
    v_dot2_f32_bf16 v97, v35, v30, v97
    v_dot2_f32_bf16 v99, v35, v35, v99
    s_add_u32 s26, s26, 4096
    buffer_load_dwordx4 a[64:67], v5, s[4:7], s26 offen offset:0
    s_waitcnt lgkmcnt(12)
    v_dot2_f32_bf16 v96, v36, v30, v96
    v_dot2_f32_bf16 v98, v36, v36, v98
    v_dot2_f32_bf16 v97, v37, v30, v97
    v_dot2_f32_bf16 v99, v37, v37, v99
    v_dot2_f32_bf16 v96, v38, v30, v96
    v_dot2_f32_bf16 v98, v38, v38, v98
    v_dot2_f32_bf16 v97, v39, v30, v97
    v_dot2_f32_bf16 v99, v39, v39, v99
    buffer_load_dwordx4 a[68:71], v5, s[4:7], s26 offen offset:1024
    s_waitcnt lgkmcnt(10)
    v_dot2_f32_bf16 v96, v40, v30, v96
    v_dot2_f32_bf16 v98, v40, v40, v98
    v_dot2_f32_bf16 v97, v41, v30, v97
    v_dot2_f32_bf16 v99, v41, v41, v99
    v_dot2_f32_bf16 v96, v42, v30, v96
    v_dot2_f32_bf16 v98, v42, v42, v98
    v_dot2_f32_bf16 v97, v43, v30, v97
    v_dot2_f32_bf16 v99, v43, v43, v99
    buffer_load_dwordx4 a[72:75], v5, s[4:7], s26 offen offset:2048
    s_waitcnt lgkmcnt(8)
    v_dot2_f32_bf16 v96, v44, v30, v96
    v_dot2_f32_bf16 v98, v44, v44, v98
    v_dot2_f32_bf16 v97, v45, v30, v97
    v_dot2_f32_bf16 v99, v45, v45, v99
    v_dot2_f32_bf16 v96, v46, v30, v96
    v_dot2_f32_bf16 v98, v46, v46, v98
    v_dot2_f32_bf16 v97, v47, v30, v97
    v_dot2_f32_bf16 v99, v47, v47, v99
    buffer_load_dwordx4 a[76:79], v5, s[4:7], s26 offen offset:3072
    s_waitcnt lgkmcnt(6)
    v_dot2_f32_bf16 v96, v48, v30, v96
    v_dot2_f32_bf16 v98, v48, v48, v98
    v_dot2_f32_bf16 v97, v49, v30, v97
    v_dot2_f32_bf16 v99, v49, v49, v99
    v_dot2_f32_bf16 v96, v50, v30, v96
    v_dot2_f32_bf16 v98, v50, v50, v98
    v_dot2_f32_bf16 v97, v51, v30, v97
    v_dot2_f32_bf16 v99, v51, v51, v99
    s_add_u32 s26, s26, 4096
    buffer_load_dwordx4 a[80:83], v5, s[4:7], s26 offen offset:0
    s_waitcnt lgkmcnt(4)
    v_dot2_f32_bf16 v96, v52, v30, v96
    v_dot2_f32_bf16 v98, v52, v52, v98
    v_dot2_f32_bf16 v97, v53, v30, v97
    v_dot2_f32_bf16 v99, v53, v53, v99
    v_dot2_f32_bf16 v96, v54, v30, v96
    v_dot2_f32_bf16 v98, v54, v54, v98
    v_dot2_f32_bf16 v97, v55, v30, v97
    v_dot2_f32_bf16 v99, v55, v55, v99
    buffer_load_dwordx4 a[84:87], v5, s[4:7], s26 offen offset:1024
    s_waitcnt lgkmcnt(2)
    v_dot2_f32_bf16 v96, v56, v30, v96
    v_dot2_f32_bf16 v98, v56, v56, v98
    v_dot2_f32_bf16 v97, v57, v30, v97
    v_dot2_f32_bf16 v99, v57, v57, v99
    v_dot2_f32_bf16 v96, v58, v30, v96
    v_dot2_f32_bf16 v98, v58, v58, v98
    v_dot2_f32_bf16 v97, v59, v30, v97
    v_dot2_f32_bf16 v99, v59, v59, v99
    buffer_load_dwordx4 a[88:91], v5, s[4:7], s26 offen offset:2048
    s_waitcnt lgkmcnt(0)
    v_dot2_f32_bf16 v96, v60, v30, v96
    v_dot2_f32_bf16 v98, v60, v60, v98
    v_dot2_f32_bf16 v97, v61, v30, v97
    v_dot2_f32_bf16 v99, v61, v61, v99
    v_dot2_f32_bf16 v96, v62, v30, v96
    v_dot2_f32_bf16 v98, v62, v62, v98
    v_dot2_f32_bf16 v97, v63, v30, v97
    v_dot2_f32_bf16 v99, v63, v63, v99
    buffer_load_dwordx4 a[92:95], v5, s[4:7], s26 offen offset:3072
    s_nop 0
    v_add_f32 v96, v96, v97
    v_add_f32 v97, v98, v99
    v_mov_b32 v100, v96
    v_mov_b32 v101, v97
    s_nop 0
    v_permlane16_swap_b32 v96, v100
    v_permlane16_swap_b32 v97, v101
    v_add_f32 v96, v96, v100
    v_add_f32 v97, v97, v101
    v_mov_b32 v100, v96
    v_mov_b32 v101, v97
    s_nop 0
    v_permlane32_swap_b32 v96, v100
    v_permlane32_swap_b32 v97, v101
    v_add_f32 v96, v96, v100
    v_add_f32 v97, v97, v101
    ds_write_b64 v27, v[96:97]
    s_waitcnt lgkmcnt(0)
    s_barrier
    v_xor_b32 v6, 256, v27
    ds_read_b64 v[98:99], v6
    ds_read_b128 v[156:159], v25 offset:0
    ds_read_b128 v[160:163], v25 offset:16
    ds_read_b128 v[164:167], v25 offset:2048
    ds_read_b128 v[168:171], v25 offset:2064
    s_waitcnt lgkmcnt(4)
    ds_read_b128 v[172:175], v25 offset:128
    ds_read_b128 v[176:179], v25 offset:144
    ds_read_b128 v[180:183], v25 offset:2176
    ds_read_b128 v[184:187], v25 offset:2192
    v_add_f32 v96, v96, v98
    v_add_f32 v97, v97, v99
    v_mul_f32 v96, 0x3b000000, v96
    v_mul_f32 v100, v96, v96
    v_mul_f32 v97, 0x3b000000, v97
    v_sub_f32 v97, v97, v100
    v_max_f32 v97, 0, v97
    v_add_f32 v97, 0x3727c5ac, v97
    v_rsq_f32 v97, v97
    s_nop 0
    v_mul_f32 v96, v96, v97
    v_sub_f32 v96, 0, v96
    v_mov_b32 v204, v97
    v_mov_b32 v206, v96
    v_mov_b32 v96, 0
    v_mov_b32 v97, 0
    v_mov_b32 v98, 0
    v_mov_b32 v99, 0
    ds_read_b128 v[188:191], v25 offset:256
    ds_read_b128 v[192:195], v25 offset:272
    ds_read_b128 v[196:199], v25 offset:2304
    ds_read_b128 v[200:203], v25 offset:2320
    v_lshlrev_b32 v140, 16, v32
    v_and_b32 v141, 0xffff0000, v32
    v_lshlrev_b32 v142, 16, v33
    v_and_b32 v143, 0xffff0000, v33
    v_lshlrev_b32 v144, 16, v34
    v_and_b32 v145, 0xffff0000, v34
    v_lshlrev_b32 v146, 16, v35
    v_and_b32 v147, 0xffff0000, v35
    s_add_u32 s26, s26, 4096
    buffer_load_dwordx4 a[96:99], v5, s[4:7], s26 offen offset:0
    v_pk_fma_f32 v[140:141], v[140:141], v[204:205], v[206:207] op_sel_hi:[1,0,0]
    v_pk_fma_f32 v[142:143], v[142:143], v[204:205], v[206:207] op_sel_hi:[1,0,0]
    v_pk_fma_f32 v[144:145], v[144:145], v[204:205], v[206:207] op_sel_hi:[1,0,0]
    v_pk_fma_f32 v[146:147], v[146:147], v[204:205], v[206:207] op_sel_hi:[1,0,0]
    s_waitcnt lgkmcnt(8)
    v_pk_fma_f32 v[140:141], v[140:141], v[164:165], v[156:157]
    v_pk_fma_f32 v[142:143], v[142:143], v[166:167], v[158:159]
    v_pk_fma_f32 v[144:145], v[144:145], v[168:169], v[160:161]
    v_pk_fma_f32 v[146:147], v[146:147], v[170:171], v[162:163]
    v_cvt_pk_bf16_f32 v64, v140, v141
    v_cvt_pk_bf16_f32 v65, v142, v143
    v_cvt_pk_bf16_f32 v66, v144, v145
    v_cvt_pk_bf16_f32 v67, v146, v147
    ds_write_b128 v26, v[64:67] offset:0
    buffer_load_dwordx4 a[100:103], v5, s[4:7], s26 offen offset:1024
    v_dot2_f32_bf16 v96, v64, v30, v96
    v_dot2_f32_bf16 v98, v64, v64, v98
    v_dot2_f32_bf16 v97, v65, v30, v97
    v_dot2_f32_bf16 v99, v65, v65, v99
    v_dot2_f32_bf16 v96, v66, v30, v96
    v_dot2_f32_bf16 v98, v66, v66, v98
    v_dot2_f32_bf16 v97, v67, v30, v97
    v_dot2_f32_bf16 v99, v67, v67, v99
    ds_read_b128 v[156:159], v25 offset:384
    ds_read_b128 v[160:163], v25 offset:400
    ds_read_b128 v[164:167], v25 offset:2432
    ds_read_b128 v[168:171], v25 offset:2448
    v_lshlrev_b32 v140, 16, v36
    v_and_b32 v141, 0xffff0000, v36
    v_lshlrev_b32 v142, 16, v37
    v_and_b32 v143, 0xffff0000, v37
    v_lshlrev_b32 v144, 16, v38
    v_and_b32 v145, 0xffff0000, v38
    v_lshlrev_b32 v146, 16, v39
    v_and_b32 v147, 0xffff0000, v39
    buffer_load_dwordx4 a[104:107], v5, s[4:7], s26 offen offset:2048
    v_pk_fma_f32 v[140:141], v[140:141], v[204:205], v[206:207] op_sel_hi:[1,0,0]
    v_pk_fma_f32 v[142:143], v[142:143], v[204:205], v[206:207] op_sel_hi:[1,0,0]
    v_pk_fma_f32 v[144:145], v[144:145], v[204:205], v[206:207] op_sel_hi:[1,0,0]
    v_pk_fma_f32 v[146:147], v[146:147], v[204:205], v[206:207] op_sel_hi:[1,0,0]
    s_waitcnt lgkmcnt(9)
    v_pk_fma_f32 v[140:141], v[140:141], v[180:181], v[172:173]
    v_pk_fma_f32 v[142:143], v[142:143], v[182:183], v[174:175]
    v_pk_fma_f32 v[144:145], v[144:145], v[184:185], v[176:177]
    v_pk_fma_f32 v[146:147], v[146:147], v[186:187], v[178:179]
    v_cvt_pk_bf16_f32 v68, v140, v141
    v_cvt_pk_bf16_f32 v69, v142, v143
    v_cvt_pk_bf16_f32 v70, v144, v145
    v_cvt_pk_bf16_f32 v71, v146, v147
    ds_write_b128 v26, v[68:71] offset:2048
    buffer_load_dwordx4 a[108:111], v5, s[4:7], s26 offen offset:3072
    v_dot2_f32_bf16 v96, v68, v30, v96
    v_dot2_f32_bf16 v98, v68, v68, v98
    v_dot2_f32_bf16 v97, v69, v30, v97
    v_dot2_f32_bf16 v99, v69, v69, v99
    v_dot2_f32_bf16 v96, v70, v30, v96
    v_dot2_f32_bf16 v98, v70, v70, v98
    v_dot2_f32_bf16 v97, v71, v30, v97
    v_dot2_f32_bf16 v99, v71, v71, v99
    ds_read_b128 v[172:175], v25 offset:512
    ds_read_b128 v[176:179], v25 offset:528
    ds_read_b128 v[180:183], v25 offset:2560
    ds_read_b128 v[184:187], v25 offset:2576
    v_lshlrev_b32 v140, 16, v40
    v_and_b32 v141, 0xffff0000, v40
    v_lshlrev_b32 v142, 16, v41
    v_and_b32 v143, 0xffff0000, v41
    v_lshlrev_b32 v144, 16, v42
    v_and_b32 v145, 0xffff0000, v42
    v_lshlrev_b32 v146, 16, v43
    v_and_b32 v147, 0xffff0000, v43
    s_add_u32 s26, s26, 4096
    buffer_load_dwordx4 a[112:115], v5, s[4:7], s26 offen offset:0
    v_pk_fma_f32 v[140:141], v[140:141], v[204:205], v[206:207] op_sel_hi:[1,0,0]
    v_pk_fma_f32 v[142:143], v[142:143], v[204:205], v[206:207] op_sel_hi:[1,0,0]
    v_pk_fma_f32 v[144:145], v[144:145], v[204:205], v[206:207] op_sel_hi:[1,0,0]
    v_pk_fma_f32 v[146:147], v[146:147], v[204:205], v[206:207] op_sel_hi:[1,0,0]
    s_waitcnt lgkmcnt(10)
    v_pk_fma_f32 v[140:141], v[140:141], v[196:197], v[188:189]
    v_pk_fma_f32 v[142:143], v[142:143], v[198:199], v[190:191]
    v_pk_fma_f32 v[144:145], v[144:145], v[200:201], v[192:193]
    v_pk_fma_f32 v[146:147], v[146:147], v[202:203], v[194:195]
    v_cvt_pk_bf16_f32 v72, v140, v141
    v_cvt_pk_bf16_f32 v73, v142, v143
    v_cvt_pk_bf16_f32 v74, v144, v145
    v_cvt_pk_bf16_f32 v75, v146, v147
    ds_write_b128 v26, v[72:75] offset:4096
    buffer_load_dwordx4 a[116:119], v5, s[4:7], s26 offen offset:1024
    v_dot2_f32_bf16 v96, v72, v30, v96
    v_dot2_f32_bf16 v98, v72, v72, v98
    v_dot2_f32_bf16 v97, v73, v30, v97
    v_dot2_f32_bf16 v99, v73, v73, v99
    v_dot2_f32_bf16 v96, v74, v30, v96
    v_dot2_f32_bf16 v98, v74, v74, v98
    v_dot2_f32_bf16 v97, v75, v30, v97
    v_dot2_f32_bf16 v99, v75, v75, v99
    ds_read_b128 v[188:191], v25 offset:640
    ds_read_b128 v[192:195], v25 offset:656
    ds_read_b128 v[196:199], v25 offset:2688
    ds_read_b128 v[200:203], v25 offset:2704
    v_lshlrev_b32 v140, 16, v44
    v_and_b32 v141, 0xffff0000, v44
    v_lshlrev_b32 v142, 16, v45
    v_and_b32 v143, 0xffff0000, v45
    v_lshlrev_b32 v144, 16, v46
    v_and_b32 v145, 0xffff0000, v46
    v_lshlrev_b32 v146, 16, v47
    v_and_b32 v147, 0xffff0000, v47
    buffer_load_dwordx4 a[120:123], v5, s[4:7], s26 offen offset:2048
    v_pk_fma_f32 v[140:141], v[140:141], v[204:205], v[206:207] op_sel_hi:[1,0,0]
    v_pk_fma_f32 v[142:143], v[142:143], v[204:205], v[206:207] op_sel_hi:[1,0,0]
    v_pk_fma_f32 v[144:145], v[144:145], v[204:205], v[206:207] op_sel_hi:[1,0,0]
    v_pk_fma_f32 v[146:147], v[146:147], v[204:205], v[206:207] op_sel_hi:[1,0,0]
    s_waitcnt lgkmcnt(10)
    v_pk_fma_f32 v[140:141], v[140:141], v[164:165], v[156:157]
    v_pk_fma_f32 v[142:143], v[142:143], v[166:167], v[158:159]
    v_pk_fma_f32 v[144:145], v[144:145], v[168:169], v[160:161]
    v_pk_fma_f32 v[146:147], v[146:147], v[170:171], v[162:163]
    v_cvt_pk_bf16_f32 v76, v140, v141
    v_cvt_pk_bf16_f32 v77, v142, v143
    v_cvt_pk_bf16_f32 v78, v144, v145
    v_cvt_pk_bf16_f32 v79, v146, v147
    ds_write_b128 v26, v[76:79] offset:6144
    buffer_load_dwordx4 a[124:127], v5, s[4:7], s26 offen offset:3072
    v_dot2_f32_bf16 v96, v76, v30, v96
    v_dot2_f32_bf16 v98, v76, v76, v98
    v_dot2_f32_bf16 v97, v77, v30, v97
    v_dot2_f32_bf16 v99, v77, v77, v99
    v_dot2_f32_bf16 v96, v78, v30, v96
    v_dot2_f32_bf16 v98, v78, v78, v98
    v_dot2_f32_bf16 v97, v79, v30, v97
    v_dot2_f32_bf16 v99, v79, v79, v99
    ds_read_b128 v[156:159], v25 offset:768
    ds_read_b128 v[160:163], v25 offset:784
    ds_read_b128 v[164:167], v25 offset:2816
    ds_read_b128 v[168:171], v25 offset:2832
    v_lshlrev_b32 v140, 16, v48
    v_and_b32 v141, 0xffff0000, v48
    v_lshlrev_b32 v142, 16, v49
    v_and_b32 v143, 0xffff0000, v49
    v_lshlrev_b32 v144, 16, v50
    v_and_b32 v145, 0xffff0000, v50
    v_lshlrev_b32 v146, 16, v51
    v_and_b32 v147, 0xffff0000, v51
    v_pk_fma_f32 v[140:141], v[140:141], v[204:205], v[206:207] op_sel_hi:[1,0,0]
    v_pk_fma_f32 v[142:143], v[142:143], v[204:205], v[206:207] op_sel_hi:[1,0,0]
    v_pk_fma_f32 v[144:145], v[144:145], v[204:205], v[206:207] op_sel_hi:[1,0,0]
    v_pk_fma_f32 v[146:147], v[146:147], v[204:205], v[206:207] op_sel_hi:[1,0,0]
    s_waitcnt lgkmcnt(10)
    v_pk_fma_f32 v[140:141], v[140:141], v[180:181], v[172:173]
    v_pk_fma_f32 v[142:143], v[142:143], v[182:183], v[174:175]
    v_pk_fma_f32 v[144:145], v[144:145], v[184:185], v[176:177]
    v_pk_fma_f32 v[146:147], v[146:147], v[186:187], v[178:179]
    v_cvt_pk_bf16_f32 v80, v140, v141
    v_cvt_pk_bf16_f32 v81, v142, v143
    v_cvt_pk_bf16_f32 v82, v144, v145
    v_cvt_pk_bf16_f32 v83, v146, v147
    ds_write_b128 v26, v[80:83] offset:8192
    v_dot2_f32_bf16 v96, v80, v30, v96
    v_dot2_f32_bf16 v98, v80, v80, v98
    v_dot2_f32_bf16 v97, v81, v30, v97
    v_dot2_f32_bf16 v99, v81, v81, v99
    v_dot2_f32_bf16 v96, v82, v30, v96
    v_dot2_f32_bf16 v98, v82, v82, v98
    v_dot2_f32_bf16 v97, v83, v30, v97
    v_dot2_f32_bf16 v99, v83, v83, v99
    ds_read_b128 v[172:175], v25 offset:896
    ds_read_b128 v[176:179], v25 offset:912
    ds_read_b128 v[180:183], v25 offset:2944
    ds_read_b128 v[184:187], v25 offset:2960
    v_lshlrev_b32 v140, 16, v52
    v_and_b32 v141, 0xffff0000, v52
    v_lshlrev_b32 v142, 16, v53
    v_and_b32 v143, 0xffff0000, v53
    v_lshlrev_b32 v144, 16, v54
    v_and_b32 v145, 0xffff0000, v54
    v_lshlrev_b32 v146, 16, v55
    v_and_b32 v147, 0xffff0000, v55
    v_pk_fma_f32 v[140:141], v[140:141], v[204:205], v[206:207] op_sel_hi:[1,0,0]
    v_pk_fma_f32 v[142:143], v[142:143], v[204:205], v[206:207] op_sel_hi:[1,0,0]
    v_pk_fma_f32 v[144:145], v[144:145], v[204:205], v[206:207] op_sel_hi:[1,0,0]
    v_pk_fma_f32 v[146:147], v[146:147], v[204:205], v[206:207] op_sel_hi:[1,0,0]
    s_waitcnt lgkmcnt(10)
    v_pk_fma_f32 v[140:141], v[140:141], v[196:197], v[188:189]
    v_pk_fma_f32 v[142:143], v[142:143], v[198:199], v[190:191]
    v_pk_fma_f32 v[144:145], v[144:145], v[200:201], v[192:193]
    v_pk_fma_f32 v[146:147], v[146:147], v[202:203], v[194:195]
    v_cvt_pk_bf16_f32 v84, v140, v141
    v_cvt_pk_bf16_f32 v85, v142, v143
    v_cvt_pk_bf16_f32 v86, v144, v145
    v_cvt_pk_bf16_f32 v87, v146, v147
    ds_write_b128 v26, v[84:87] offset:10240
    v_dot2_f32_bf16 v96, v84, v30, v96
    v_dot2_f32_bf16 v98, v84, v84, v98
    v_dot2_f32_bf16 v97, v85, v30, v97
    v_dot2_f32_bf16 v99, v85, v85, v99
    v_dot2_f32_bf16 v96, v86, v30, v96
    v_dot2_f32_bf16 v98, v86, v86, v98
    v_dot2_f32_bf16 v97, v87, v30, v97
    v_dot2_f32_bf16 v99, v87, v87, v99
    v_lshlrev_b32 v140, 16, v56
    v_and_b32 v141, 0xffff0000, v56
    v_lshlrev_b32 v142, 16, v57
    v_and_b32 v143, 0xffff0000, v57
    v_lshlrev_b32 v144, 16, v58
    v_and_b32 v145, 0xffff0000, v58
    v_lshlrev_b32 v146, 16, v59
    v_and_b32 v147, 0xffff0000, v59
    v_pk_fma_f32 v[140:141], v[140:141], v[204:205], v[206:207] op_sel_hi:[1,0,0]
    v_pk_fma_f32 v[142:143], v[142:143], v[204:205], v[206:207] op_sel_hi:[1,0,0]
    v_pk_fma_f32 v[144:145], v[144:145], v[204:205], v[206:207] op_sel_hi:[1,0,0]
    v_pk_fma_f32 v[146:147], v[146:147], v[204:205], v[206:207] op_sel_hi:[1,0,0]
    s_waitcnt lgkmcnt(6)
    v_pk_fma_f32 v[140:141], v[140:141], v[164:165], v[156:157]
    v_pk_fma_f32 v[142:143], v[142:143], v[166:167], v[158:159]
    v_pk_fma_f32 v[144:145], v[144:145], v[168:169], v[160:161]
    v_pk_fma_f32 v[146:147], v[146:147], v[170:171], v[162:163]
    v_cvt_pk_bf16_f32 v88, v140, v141
    v_cvt_pk_bf16_f32 v89, v142, v143
    v_cvt_pk_bf16_f32 v90, v144, v145
    v_cvt_pk_bf16_f32 v91, v146, v147
    ds_write_b128 v26, v[88:91] offset:12288
    v_dot2_f32_bf16 v96, v88, v30, v96
    v_dot2_f32_bf16 v98, v88, v88, v98
    v_dot2_f32_bf16 v97, v89, v30, v97
    v_dot2_f32_bf16 v99, v89, v89, v99
    v_dot2_f32_bf16 v96, v90, v30, v96
    v_dot2_f32_bf16 v98, v90, v90, v98
    v_dot2_f32_bf16 v97, v91, v30, v97
    v_dot2_f32_bf16 v99, v91, v91, v99
    v_lshlrev_b32 v140, 16, v60
    v_and_b32 v141, 0xffff0000, v60
    v_lshlrev_b32 v142, 16, v61
    v_and_b32 v143, 0xffff0000, v61
    v_lshlrev_b32 v144, 16, v62
    v_and_b32 v145, 0xffff0000, v62
    v_lshlrev_b32 v146, 16, v63
    v_and_b32 v147, 0xffff0000, v63
    v_pk_fma_f32 v[140:141], v[140:141], v[204:205], v[206:207] op_sel_hi:[1,0,0]
    v_pk_fma_f32 v[142:143], v[142:143], v[204:205], v[206:207] op_sel_hi:[1,0,0]
    v_pk_fma_f32 v[144:145], v[144:145], v[204:205], v[206:207] op_sel_hi:[1,0,0]
    v_pk_fma_f32 v[146:147], v[146:147], v[204:205], v[206:207] op_sel_hi:[1,0,0]
    s_waitcnt lgkmcnt(2)
    v_pk_fma_f32 v[140:141], v[140:141], v[180:181], v[172:173]
    v_pk_fma_f32 v[142:143], v[142:143], v[182:183], v[174:175]
    v_pk_fma_f32 v[144:145], v[144:145], v[184:185], v[176:177]
    v_pk_fma_f32 v[146:147], v[146:147], v[186:187], v[178:179]
    v_cvt_pk_bf16_f32 v92, v140, v141
    v_cvt_pk_bf16_f32 v93, v142, v143
    v_cvt_pk_bf16_f32 v94, v144, v145
    v_cvt_pk_bf16_f32 v95, v146, v147
    ds_write_b128 v26, v[92:95] offset:14336
    v_dot2_f32_bf16 v96, v92, v30, v96
    v_dot2_f32_bf16 v98, v92, v92, v98
    v_dot2_f32_bf16 v97, v93, v30, v97
    v_dot2_f32_bf16 v99, v93, v93, v99
    v_dot2_f32_bf16 v96, v94, v30, v96
    v_dot2_f32_bf16 v98, v94, v94, v98
    v_dot2_f32_bf16 v97, v95, v30, v97
    v_dot2_f32_bf16 v99, v95, v95, v99
    s_nop 1
    v_add_f32 v96, v96, v97
    v_add_f32 v97, v98, v99
    v_mov_b32 v100, v96
    v_mov_b32 v101, v97
    s_nop 0
    v_permlane16_swap_b32 v96, v100
    v_permlane16_swap_b32 v97, v101
    v_add_f32 v96, v96, v100
    v_add_f32 v97, v97, v101
    v_mov_b32 v100, v96
    v_mov_b32 v101, v97
    s_nop 0
    v_permlane32_swap_b32 v96, v100
    v_permlane32_swap_b32 v97, v101
    v_add_f32 v96, v96, v100
    v_add_f32 v97, v97, v101
    ds_write_b64 v27, v[96:97] offset:512
    s_waitcnt vmcnt(0)
    s_lshr_b32 s44, s93, 1
    s_cmp_eq_u32 s44, s60
    s_cbranch_scc0 .Lmlp_ke_sdone_5
    s_lshl_b32 s44, s90, 16
    s_lshl_b32 s45, s93, 14
    s_add_u32 s44, s44, s45
    s_and_b32 s45, s92, 1
    s_lshl_b32 s45, s45, 1
    s_add_u32 s45, s45, s47
    s_lshl_b32 s45, s45, 10
    s_add_u32 s44, s44, s45
    s_bitcmp1_b32 s93, 0
    s_cbranch_scc1 .Lmlp_ke_odd_4
    buffer_store_dwordx4 v[32:35], v5, s[76:79], s44 offen sc1
    s_add_u32 s44, s44, 4096
    buffer_store_dwordx4 v[36:39], v5, s[76:79], s44 offen sc1
    s_add_u32 s44, s44, 4096
    buffer_store_dwordx4 v[40:43], v5, s[76:79], s44 offen sc1
    s_add_u32 s44, s44, 4096
    buffer_store_dwordx4 v[44:47], v5, s[76:79], s44 offen sc1
    s_branch .Lmlp_ke_sdone_5
.Lmlp_ke_odd_4:
    buffer_store_dwordx4 v[48:51], v5, s[76:79], s44 offen sc1
    s_add_u32 s44, s44, 4096
    buffer_store_dwordx4 v[52:55], v5, s[76:79], s44 offen sc1
    s_add_u32 s44, s44, 4096
    buffer_store_dwordx4 v[56:59], v5, s[76:79], s44 offen sc1
    s_add_u32 s44, s44, 4096
    buffer_store_dwordx4 v[60:63], v5, s[76:79], s44 offen sc1
.Lmlp_ke_sdone_5:
    s_waitcnt lgkmcnt(0)
    s_barrier
    v_lshlrev_b32 v6, 3, v3
    v_add_u32 v6, 70144, v6
    ds_read_b64 v[96:97], v6 offset:0
    ds_read_b64 v[98:99], v6 offset:128
    ds_read_b64 v[100:101], v6 offset:256
    ds_read_b64 v[102:103], v6 offset:384
    ds_read_b128 v[104:107], v28 offset:0
    ds_read_b128 v[108:111], v28 offset:256
    ds_read_b128 v[112:115], v28 offset:2048
    ds_read_b128 v[116:119], v28 offset:2304
    s_waitcnt lgkmcnt(4)
    v_pk_add_f32 v[96:97], v[96:97], v[100:101]
    v_pk_add_f32 v[98:99], v[98:99], v[102:103]
    ds_read_b128 v[120:123], v28 offset:4096
    ds_read_b128 v[124:127], v28 offset:4352
    s_waitcnt lgkmcnt(4)
    v_mfma_f32_16x16x32_bf16 v[140:143], a[0:3], v[104:107], 0
    v_mfma_f32_16x16x32_bf16 v[144:147], a[4:7], v[104:107], 0
    v_mfma_f32_16x16x32_bf16 v[148:151], a[0:3], v[108:111], 0
    v_mfma_f32_16x16x32_bf16 v[152:155], a[4:7], v[108:111], 0
    s_mov_b32 s27, 0
    buffer_load_dwordx4 a[128:131], v5, s[8:11], s27 offen offset:0
    v_mul_f32 v96, 0xbb000000, v96
    v_mul_f32 v100, v96, v96
    v_mul_f32 v97, 0x3b000000, v97
    v_sub_f32 v97, v97, v100
    v_max_f32 v97, 0, v97
    v_add_f32 v97, 0x3727c5ac, v97
    v_mul_f32 v98, 0xbb000000, v98
    v_mul_f32 v100, v98, v98
    v_mul_f32 v99, 0x3b000000, v99
    v_sub_f32 v99, v99, v100
    v_max_f32 v99, 0, v99
    v_add_f32 v99, 0x3727c5ac, v99
    ds_read_b128 v[128:131], v28 offset:6144
    ds_read_b128 v[132:135], v28 offset:6400
    s_waitcnt lgkmcnt(4)
    v_mfma_f32_16x16x32_bf16 v[140:143], a[8:11], v[112:115], v[140:143]
    v_mfma_f32_16x16x32_bf16 v[144:147], a[12:15], v[112:115], v[144:147]
    v_mfma_f32_16x16x32_bf16 v[148:151], a[8:11], v[116:119], v[148:151]
    v_mfma_f32_16x16x32_bf16 v[152:155], a[12:15], v[116:119], v[152:155]
    buffer_load_dwordx4 a[132:135], v5, s[8:11], s27 offen offset:1024
    ds_read_b128 v[104:107], v28 offset:8192
    ds_read_b128 v[108:111], v28 offset:8448
    s_waitcnt lgkmcnt(4)
    v_mfma_f32_16x16x32_bf16 v[140:143], a[16:19], v[120:123], v[140:143]
    v_mfma_f32_16x16x32_bf16 v[144:147], a[20:23], v[120:123], v[144:147]
    v_mfma_f32_16x16x32_bf16 v[148:151], a[16:19], v[124:127], v[148:151]
    v_mfma_f32_16x16x32_bf16 v[152:155], a[20:23], v[124:127], v[152:155]
    buffer_load_dwordx4 a[136:139], v5, s[8:11], s27 offen offset:2048
    v_add_f32 v8, v8, v16
    v_add_f32 v9, v9, v17
    v_add_f32 v10, v10, v18
    v_add_f32 v11, v11, v19
    v_add_f32 v12, v12, v20
    v_add_f32 v13, v13, v21
    v_add_f32 v14, v14, v22
    v_add_f32 v15, v15, v23
    ds_read_b128 v[112:115], v28 offset:10240
    ds_read_b128 v[116:119], v28 offset:10496
    s_waitcnt lgkmcnt(4)
    v_mfma_f32_16x16x32_bf16 v[140:143], a[24:27], v[128:131], v[140:143]
    v_mfma_f32_16x16x32_bf16 v[144:147], a[28:31], v[128:131], v[144:147]
    v_mfma_f32_16x16x32_bf16 v[148:151], a[24:27], v[132:135], v[148:151]
    v_mfma_f32_16x16x32_bf16 v[152:155], a[28:31], v[132:135], v[152:155]
    buffer_load_dwordx4 a[140:143], v5, s[8:11], s27 offen offset:3072
    ds_read_b128 v[120:123], v28 offset:12288
    ds_read_b128 v[124:127], v28 offset:12544
    s_waitcnt lgkmcnt(4)
    v_mfma_f32_16x16x32_bf16 v[140:143], a[32:35], v[104:107], v[140:143]
    v_mfma_f32_16x16x32_bf16 v[144:147], a[36:39], v[104:107], v[144:147]
    v_mfma_f32_16x16x32_bf16 v[148:151], a[32:35], v[108:111], v[148:151]
    v_mfma_f32_16x16x32_bf16 v[152:155], a[36:39], v[108:111], v[152:155]
    s_add_u32 s27, s27, 4096
    buffer_load_dwordx4 a[144:147], v5, s[8:11], s27 offen offset:0
    ds_read_b128 v[128:131], v28 offset:14336
    ds_read_b128 v[132:135], v28 offset:14592
    s_waitcnt lgkmcnt(4)
    v_mfma_f32_16x16x32_bf16 v[140:143], a[40:43], v[112:115], v[140:143]
    v_mfma_f32_16x16x32_bf16 v[144:147], a[44:47], v[112:115], v[144:147]
    v_mfma_f32_16x16x32_bf16 v[148:151], a[40:43], v[116:119], v[148:151]
    v_mfma_f32_16x16x32_bf16 v[152:155], a[44:47], v[116:119], v[152:155]
    buffer_load_dwordx4 a[148:151], v5, s[8:11], s27 offen offset:1024
    ds_read_b128 v[104:107], v28 offset:16384
    ds_read_b128 v[108:111], v28 offset:16640
    s_waitcnt lgkmcnt(4)
    v_mfma_f32_16x16x32_bf16 v[140:143], a[48:51], v[120:123], v[140:143]
    v_mfma_f32_16x16x32_bf16 v[144:147], a[52:55], v[120:123], v[144:147]
    v_mfma_f32_16x16x32_bf16 v[148:151], a[48:51], v[124:127], v[148:151]
    v_mfma_f32_16x16x32_bf16 v[152:155], a[52:55], v[124:127], v[152:155]
    buffer_load_dwordx4 a[152:155], v5, s[8:11], s27 offen offset:2048
    ds_read_b128 v[112:115], v28 offset:18432
    ds_read_b128 v[116:119], v28 offset:18688
    s_waitcnt lgkmcnt(4)
    v_mfma_f32_16x16x32_bf16 v[140:143], a[56:59], v[128:131], v[140:143]
    v_mfma_f32_16x16x32_bf16 v[144:147], a[60:63], v[128:131], v[144:147]
    v_mfma_f32_16x16x32_bf16 v[148:151], a[56:59], v[132:135], v[148:151]
    v_mfma_f32_16x16x32_bf16 v[152:155], a[60:63], v[132:135], v[152:155]
    buffer_load_dwordx4 a[156:159], v5, s[8:11], s27 offen offset:3072
    ds_read_b128 v[120:123], v28 offset:20480
    ds_read_b128 v[124:127], v28 offset:20736
    s_waitcnt lgkmcnt(4)
    v_mfma_f32_16x16x32_bf16 v[140:143], a[64:67], v[104:107], v[140:143]
    v_mfma_f32_16x16x32_bf16 v[144:147], a[68:71], v[104:107], v[144:147]
    v_mfma_f32_16x16x32_bf16 v[148:151], a[64:67], v[108:111], v[148:151]
    v_mfma_f32_16x16x32_bf16 v[152:155], a[68:71], v[108:111], v[152:155]
    s_add_u32 s27, s27, 4096
    buffer_load_dwordx4 a[160:163], v5, s[8:11], s27 offen offset:0
    ds_read_b128 v[128:131], v28 offset:22528
    ds_read_b128 v[132:135], v28 offset:22784
    s_waitcnt lgkmcnt(4)
    v_mfma_f32_16x16x32_bf16 v[140:143], a[72:75], v[112:115], v[140:143]
    v_mfma_f32_16x16x32_bf16 v[144:147], a[76:79], v[112:115], v[144:147]
    v_mfma_f32_16x16x32_bf16 v[148:151], a[72:75], v[116:119], v[148:151]
    v_mfma_f32_16x16x32_bf16 v[152:155], a[76:79], v[116:119], v[152:155]
    buffer_load_dwordx4 a[164:167], v5, s[8:11], s27 offen offset:1024
    ds_read_b128 v[104:107], v28 offset:24576
    ds_read_b128 v[108:111], v28 offset:24832
    s_waitcnt lgkmcnt(4)
    v_mfma_f32_16x16x32_bf16 v[140:143], a[80:83], v[120:123], v[140:143]
    v_mfma_f32_16x16x32_bf16 v[144:147], a[84:87], v[120:123], v[144:147]
    v_mfma_f32_16x16x32_bf16 v[148:151], a[80:83], v[124:127], v[148:151]
    v_mfma_f32_16x16x32_bf16 v[152:155], a[84:87], v[124:127], v[152:155]
    buffer_load_dwordx4 a[168:171], v5, s[8:11], s27 offen offset:2048
    ds_read_b128 v[112:115], v28 offset:26624
    ds_read_b128 v[116:119], v28 offset:26880
    s_waitcnt lgkmcnt(4)
    v_mfma_f32_16x16x32_bf16 v[140:143], a[88:91], v[128:131], v[140:143]
    v_mfma_f32_16x16x32_bf16 v[144:147], a[92:95], v[128:131], v[144:147]
    v_mfma_f32_16x16x32_bf16 v[148:151], a[88:91], v[132:135], v[148:151]
    v_mfma_f32_16x16x32_bf16 v[152:155], a[92:95], v[132:135], v[152:155]
    buffer_load_dwordx4 a[172:175], v5, s[8:11], s27 offen offset:3072
    ds_read_b128 v[120:123], v28 offset:28672
    ds_read_b128 v[124:127], v28 offset:28928
    s_waitcnt lgkmcnt(4)
    v_mfma_f32_16x16x32_bf16 v[140:143], a[96:99], v[104:107], v[140:143]
    v_mfma_f32_16x16x32_bf16 v[144:147], a[100:103], v[104:107], v[144:147]
    v_mfma_f32_16x16x32_bf16 v[148:151], a[96:99], v[108:111], v[148:151]
    v_mfma_f32_16x16x32_bf16 v[152:155], a[100:103], v[108:111], v[152:155]
    s_add_u32 s27, s27, 4096
    buffer_load_dwordx4 a[176:179], v5, s[8:11], s27 offen offset:0
    ds_read_b128 v[128:131], v28 offset:30720
    ds_read_b128 v[132:135], v28 offset:30976
    s_waitcnt lgkmcnt(4)
    v_mfma_f32_16x16x32_bf16 v[140:143], a[104:107], v[112:115], v[140:143]
    v_mfma_f32_16x16x32_bf16 v[144:147], a[108:111], v[112:115], v[144:147]
    v_mfma_f32_16x16x32_bf16 v[148:151], a[104:107], v[116:119], v[148:151]
    v_mfma_f32_16x16x32_bf16 v[152:155], a[108:111], v[116:119], v[152:155]
    buffer_load_dwordx4 a[180:183], v5, s[8:11], s27 offen offset:1024
    s_waitcnt lgkmcnt(2)
    v_mfma_f32_16x16x32_bf16 v[140:143], a[112:115], v[120:123], v[140:143]
    v_mfma_f32_16x16x32_bf16 v[144:147], a[116:119], v[120:123], v[144:147]
    v_mfma_f32_16x16x32_bf16 v[148:151], a[112:115], v[124:127], v[148:151]
    v_mfma_f32_16x16x32_bf16 v[152:155], a[116:119], v[124:127], v[152:155]
    buffer_load_dwordx4 a[184:187], v5, s[8:11], s27 offen offset:2048
    s_waitcnt lgkmcnt(0)
    v_mfma_f32_16x16x32_bf16 v[140:143], a[120:123], v[128:131], v[140:143]
    v_mfma_f32_16x16x32_bf16 v[144:147], a[124:127], v[128:131], v[144:147]
    v_mfma_f32_16x16x32_bf16 v[148:151], a[120:123], v[132:135], v[148:151]
    v_mfma_f32_16x16x32_bf16 v[152:155], a[124:127], v[132:135], v[152:155]
    buffer_load_dwordx4 a[188:191], v5, s[8:11], s27 offen offset:3072
    v_rsq_f32 v116, v97
    v_mov_b32 v100, v96
    v_mul_f32 v106, v97, v116
    v_mul_f32 v102, 0xc0135761, v116
    v_mul_f32 v104, v116, v116
    v_mul_f32 v104, v104, v116
    v_mul_f32 v104, 0xbdd2d3e8, v104
    v_rsq_f32 v116, v99
    v_mov_b32 v108, v98
    v_mul_f32 v114, v99, v116
    v_mul_f32 v110, 0xc0135761, v116
    v_mul_f32 v112, v116, v116
    v_mul_f32 v112, v112, v116
    v_mul_f32 v112, 0xbdd2d3e8, v112
    s_lshl_b32 s44, s93, 2
    s_add_u32 s44, s44, s42
    s_lshl_b32 s44, s44, 11
    s_lshl_b32 s45, s92, 15
    s_add_u32 s44, s44, s45
    s_mov_b32 s61, s44
    v_pk_fma_f32 v[140:141], v[8:9], v[100:101], v[140:141] op_sel_hi:[1,0,1]
    v_pk_fma_f32 v[142:143], v[10:11], v[100:101], v[142:143] op_sel_hi:[1,0,1]
    v_pk_fma_f32 v[144:145], v[12:13], v[100:101], v[144:145] op_sel_hi:[1,0,1]
    v_pk_fma_f32 v[146:147], v[14:15], v[100:101], v[146:147] op_sel_hi:[1,0,1]
    v_pk_mul_f32 v[120:121], v[140:141], v[140:141]
    v_pk_mul_f32 v[122:123], v[142:143], v[142:143]
    v_pk_mul_f32 v[124:125], v[144:145], v[144:145]
    v_pk_mul_f32 v[126:127], v[146:147], v[146:147]
    v_pk_fma_f32 v[120:121], v[120:121], v[104:105], v[102:103] op_sel_hi:[1,0,0]
    v_pk_fma_f32 v[122:123], v[122:123], v[104:105], v[102:103] op_sel_hi:[1,0,0]
    v_pk_fma_f32 v[124:125], v[124:125], v[104:105], v[102:103] op_sel_hi:[1,0,0]
    v_pk_fma_f32 v[126:127], v[126:127], v[104:105], v[102:103] op_sel_hi:[1,0,0]
    v_pk_mul_f32 v[120:121], v[120:121], v[140:141]
    v_pk_mul_f32 v[122:123], v[122:123], v[142:143]
    v_pk_mul_f32 v[124:125], v[124:125], v[144:145]
    v_pk_mul_f32 v[126:127], v[126:127], v[146:147]
    v_exp_f32 v120, v120
    v_exp_f32 v121, v121
    v_exp_f32 v122, v122
    v_exp_f32 v123, v123
    v_exp_f32 v124, v124
    v_exp_f32 v125, v125
    v_exp_f32 v126, v126
    v_exp_f32 v127, v127
    v_pk_fma_f32 v[120:121], v[120:121], v[106:107], v[106:107] op_sel_hi:[1,0,0]
    v_pk_fma_f32 v[122:123], v[122:123], v[106:107], v[106:107] op_sel_hi:[1,0,0]
    v_pk_fma_f32 v[124:125], v[124:125], v[106:107], v[106:107] op_sel_hi:[1,0,0]
    v_pk_fma_f32 v[126:127], v[126:127], v[106:107], v[106:107] op_sel_hi:[1,0,0]
    v_rcp_f32 v120, v120
    v_rcp_f32 v121, v121
    v_rcp_f32 v122, v122
    v_rcp_f32 v123, v123
    v_rcp_f32 v124, v124
    v_rcp_f32 v125, v125
    v_rcp_f32 v126, v126
    v_rcp_f32 v127, v127
    v_pk_mul_f32 v[140:141], v[140:141], v[120:121]
    v_pk_mul_f32 v[142:143], v[142:143], v[122:123]
    v_pk_mul_f32 v[144:145], v[144:145], v[124:125]
    v_pk_mul_f32 v[146:147], v[146:147], v[126:127]
    v_cvt_pk_bf16_f32 v32, v140, v141
    v_cvt_pk_bf16_f32 v33, v142, v143
    v_cvt_pk_bf16_f32 v34, v144, v145
    v_cvt_pk_bf16_f32 v35, v146, v147
    buffer_store_dwordx4 v[32:35], v5, s[68:71], s44 offen offset:0 sc1
    v_pk_fma_f32 v[148:149], v[8:9], v[108:109], v[148:149] op_sel_hi:[1,0,1]
    v_pk_fma_f32 v[150:151], v[10:11], v[108:109], v[150:151] op_sel_hi:[1,0,1]
    v_pk_fma_f32 v[152:153], v[12:13], v[108:109], v[152:153] op_sel_hi:[1,0,1]
    v_pk_fma_f32 v[154:155], v[14:15], v[108:109], v[154:155] op_sel_hi:[1,0,1]
    v_pk_mul_f32 v[120:121], v[148:149], v[148:149]
    v_pk_mul_f32 v[122:123], v[150:151], v[150:151]
    v_pk_mul_f32 v[124:125], v[152:153], v[152:153]
    v_pk_mul_f32 v[126:127], v[154:155], v[154:155]
    v_pk_fma_f32 v[120:121], v[120:121], v[112:113], v[110:111] op_sel_hi:[1,0,0]
    v_pk_fma_f32 v[122:123], v[122:123], v[112:113], v[110:111] op_sel_hi:[1,0,0]
    v_pk_fma_f32 v[124:125], v[124:125], v[112:113], v[110:111] op_sel_hi:[1,0,0]
    v_pk_fma_f32 v[126:127], v[126:127], v[112:113], v[110:111] op_sel_hi:[1,0,0]
    v_pk_mul_f32 v[120:121], v[120:121], v[148:149]
    v_pk_mul_f32 v[122:123], v[122:123], v[150:151]
    v_pk_mul_f32 v[124:125], v[124:125], v[152:153]
    v_pk_mul_f32 v[126:127], v[126:127], v[154:155]
    v_exp_f32 v120, v120
    v_exp_f32 v121, v121
    v_exp_f32 v122, v122
    v_exp_f32 v123, v123
    v_exp_f32 v124, v124
    v_exp_f32 v125, v125
    v_exp_f32 v126, v126
    v_exp_f32 v127, v127
    v_pk_fma_f32 v[120:121], v[120:121], v[114:115], v[114:115] op_sel_hi:[1,0,0]
    v_pk_fma_f32 v[122:123], v[122:123], v[114:115], v[114:115] op_sel_hi:[1,0,0]
    v_pk_fma_f32 v[124:125], v[124:125], v[114:115], v[114:115] op_sel_hi:[1,0,0]
    v_pk_fma_f32 v[126:127], v[126:127], v[114:115], v[114:115] op_sel_hi:[1,0,0]
    v_rcp_f32 v120, v120
    v_rcp_f32 v121, v121
    v_rcp_f32 v122, v122
    v_rcp_f32 v123, v123
    v_rcp_f32 v124, v124
    v_rcp_f32 v125, v125
    v_rcp_f32 v126, v126
    v_rcp_f32 v127, v127
    v_pk_mul_f32 v[148:149], v[148:149], v[120:121]
    v_pk_mul_f32 v[150:151], v[150:151], v[122:123]
    v_pk_mul_f32 v[152:153], v[152:153], v[124:125]
    v_pk_mul_f32 v[154:155], v[154:155], v[126:127]
    v_cvt_pk_bf16_f32 v36, v148, v149
    v_cvt_pk_bf16_f32 v37, v150, v151
    v_cvt_pk_bf16_f32 v38, v152, v153
    v_cvt_pk_bf16_f32 v39, v154, v155
    buffer_store_dwordx4 v[36:39], v5, s[68:71], s44 offen offset:1024 sc1
    s_waitcnt vmcnt(0)
    s_barrier
    s_cmp_eq_u32 s42, 0
    s_cbranch_scc0 .Lmlp_ke_pub_6
    s_lshr_b32 s44, s25, 2
    s_lshl_b32 s44, s44, 6
    s_and_b32 s45, s25, 3
    s_lshl_b32 s45, s45, 2
    s_add_u32 s44, s44, s45
    s_add_u32 s44, s44, 0
    v_mov_b32 v6, s24
    v_mov_b32 v7, 0x7ff00000
    v_cmp_eq_u32 vcc, 0, v2
    s_nop 1
    v_cndmask_b32 v7, v7, v2, vcc
    buffer_store_dword v6, v7, s[20:23], s44 offen sc1
.Lmlp_ke_pub_6:
    s_add_u32 s27, s27, 4096
    buffer_load_dwordx4 a[192:195], v5, s[8:11], s27 offen offset:0
    buffer_load_dwordx4 a[196:199], v5, s[8:11], s27 offen offset:1024
    buffer_load_dwordx4 a[200:203], v5, s[8:11], s27 offen offset:2048
    buffer_load_dwordx4 a[204:207], v5, s[8:11], s27 offen offset:3072
    s_add_u32 s27, s27, 4096
    buffer_load_dwordx4 a[208:211], v5, s[8:11], s27 offen offset:0
    buffer_load_dwordx4 a[212:215], v5, s[8:11], s27 offen offset:1024
    buffer_load_dwordx4 a[216:219], v5, s[8:11], s27 offen offset:2048
    buffer_load_dwordx4 a[220:223], v5, s[8:11], s27 offen offset:3072
    s_add_u32 s27, s27, 4096
    buffer_load_dwordx4 a[224:227], v5, s[8:11], s27 offen offset:0
    buffer_load_dwordx4 a[228:231], v5, s[8:11], s27 offen offset:1024
    buffer_load_dwordx4 a[232:235], v5, s[8:11], s27 offen offset:2048
    buffer_load_dwordx4 a[236:239], v5, s[8:11], s27 offen offset:3072
    s_add_u32 s27, s27, 4096
    buffer_load_dwordx4 a[240:243], v5, s[8:11], s27 offen offset:0
    buffer_load_dwordx4 a[244:247], v5, s[8:11], s27 offen offset:1024
    buffer_load_dwordx4 a[248:251], v5, s[8:11], s27 offen offset:2048
    buffer_load_dwordx4 a[252:255], v5, s[8:11], s27 offen offset:3072
    s_add_u32 s48, s40, 0x900000
    s_addc_u32 s49, s41, 0
    s_mov_b32 s50, 0x200000
    s_mov_b32 s51, 0x20000
    s_add_u32 s64, s40, 0xf00000
    s_addc_u32 s65, s41, 0
    s_mov_b32 s66, 0x200000
    s_mov_b32 s67, 0x20000
    s_add_u32 s68, s40, 0x1c10000
    s_addc_u32 s69, s41, 0
    s_mov_b32 s70, 0x10000
    s_mov_b32 s71, 0x20000
    s_lshr_b32 s44, s42, 1
    s_add_u32 s44, s44, 1
    s_sub_u32 s45, 0, s44
    s_bitcmp1_b32 s42, 0
    s_cselect_b32 s47, s44, s45
    s_add_u32 s44, s94, s47
    v_add_u32 v6, s44, v3
    v_lshrrev_b32 v8, 5, v6
    v_lshlrev_b32 v8, 15, v8
    v_bfe_u32 v7, v6, 4, 1
    v_lshl_add_u32 v8, v7, 10, v8
    v_and_b32 v7, 15, v6
    v_lshl_add_u32 v8, v7, 4, v8
    v_lshl_add_u32 v8, v4, 8, v8
    v_mov_b32 v7, 0x7ff00000
    v_cmp_gt_u32 vcc, 2048, v6
    s_nop 1
    v_cndmask_b32 v8, v7, v8, vcc
    v_add_u32 v6, s44, v3
    v_add_u32 v6, 16, v6
    v_lshrrev_b32 v9, 5, v6
    v_lshlrev_b32 v9, 15, v9
    v_bfe_u32 v7, v6, 4, 1
    v_lshl_add_u32 v9, v7, 10, v9
    v_and_b32 v7, 15, v6
    v_lshl_add_u32 v9, v7, 4, v9
    v_lshl_add_u32 v9, v4, 8, v9
    v_mov_b32 v7, 0x7ff00000
    v_cmp_gt_u32 vcc, 2048, v6
    s_nop 1
    v_cndmask_b32 v9, v7, v9, vcc
    s_lshl_b32 s60, s93, 2
    s_add_u32 s60, s60, s42
    s_lshl_b32 s44, s60, 11
    s_add_u32 s44, s44, 32768
    v_lshlrev_b32 v11, 9, v4
    v_lshl_add_u32 v11, v3, 4, v11
    v_add_u32 v11, s44, v11
    s_lshl_b32 s60, s60, 12
    s_lshl_b32 s44, s90, 16
    s_add_u32 s60, s60, s44
    s_and_b32 s44, s92, 1
    s_lshl_b32 s44, s44, 11
    s_add_u32 s60, s60, s44
    ds_read_b128 v[12:15], v11
    ds_read_b128 v[16:19], v11 offset:256
    s_lshl_b32 s43, s92, 2
    s_sub_u32 s43, s43, 4
    s_cmp_eq_u32 s42, 0
    s_cbranch_scc0 .Lmlp_ke_aw_7
    s_ashr_i32 s44, s43, 2
    s_add_i32 s45, s44, 0
    s_max_i32 s45, s45, 0
    s_min_i32 s45, s45, 63
    s_lshl_b32 s45, s45, 6
    s_add_u32 s45, s45, 0x1d00000
    s_add_u32 s80, s40, s45
    s_addc_u32 s81, s41, 0
    s_add_i32 s45, s44, 1
    s_max_i32 s45, s45, 0
    s_min_i32 s45, s45, 63
    s_lshl_b32 s45, s45, 6
    s_add_u32 s45, s45, 0x1d00000
    s_add_u32 s82, s40, s45
    s_addc_u32 s83, s41, 0
    s_add_i32 s45, s44, 2
    s_max_i32 s45, s45, 0
    s_min_i32 s45, s45, 63
    s_lshl_b32 s45, s45, 6
    s_add_u32 s45, s45, 0x1d00000
    s_add_u32 s84, s40, s45
    s_addc_u32 s85, s41, 0
    s_mov_b32 s44, 0
.Lmlp_ke_poll_8:
    s_load_dwordx4 s[4:7], s[80:81], 0 glc
    s_load_dwordx4 s[96:99], s[82:83], 0 glc
    s_load_dwordx4 s[76:79], s[84:85], 0 glc
    s_waitcnt lgkmcnt(0)
    s_and_b32 s4, s4, s5
    s_and_b32 s6, s6, s7
    s_and_b32 s4, s4, s6
    s_and_b32 s96, s96, s97
    s_and_b32 s98, s98, s99
    s_and_b32 s96, s96, s98
    s_and_b32 s4, s4, s96
    s_and_b32 s76, s76, s77
    s_and_b32 s78, s78, s79
    s_and_b32 s76, s76, s78
    s_and_b32 s4, s4, s76
    s_cmp_eq_u32 s4, s24
    s_cbranch_scc1 .Lmlp_ke_pout_9
    s_add_u32 s44, s44, 1
    s_cmp_lt_u32 s44, 0x40000
    s_cbranch_scc1 .Lmlp_ke_poll_8
.Lmlp_ke_pout_9:
.Lmlp_ke_aw_7:
    s_barrier
    s_lshl_b32 s46, s42, 13
    s_lshl_b32 s45, s42, 13
    s_add_u32 m0, s46, 0
    s_nop 0
    buffer_load_dwordx4 v8, s[48:51], s45 offen sc1 lds
    s_add_u32 m0, s46, 1024
    s_nop 0
    buffer_load_dwordx4 v9, s[48:51], s45 offen sc1 lds
    s_add_u32 s45, s45, 2048
    s_add_u32 m0, s46, 2048
    s_nop 0
    buffer_load_dwordx4 v8, s[48:51], s45 offen sc1 lds
    s_add_u32 m0, s46, 3072
    s_nop 0
    buffer_load_dwordx4 v9, s[48:51], s45 offen sc1 lds
    s_add_u32 s45, s45, 2048
    s_add_u32 m0, s46, 4096
    s_nop 0
    buffer_load_dwordx4 v8, s[48:51], s45 offen sc1 lds
    s_add_u32 m0, s46, 5120
    s_nop 0
    buffer_load_dwordx4 v9, s[48:51], s45 offen sc1 lds
    s_add_u32 s45, s45, 2048
    s_add_u32 m0, s46, 6144
    s_nop 0
    buffer_load_dwordx4 v8, s[48:51], s45 offen sc1 lds
    s_add_u32 m0, s46, 7168
    s_nop 0
    buffer_load_dwordx4 v9, s[48:51], s45 offen sc1 lds
    s_mov_b32 s28, 0
    buffer_load_dwordx4 a[0:3], v5, s[12:15], s28 offen offset:0
    buffer_load_dwordx4 a[4:7], v5, s[12:15], s28 offen offset:1024
    buffer_load_dwordx4 a[8:11], v5, s[12:15], s28 offen offset:2048
    buffer_load_dwordx4 a[12:15], v5, s[12:15], s28 offen offset:3072
    s_add_u32 s28, s28, 4096
    buffer_load_dwordx4 a[16:19], v5, s[12:15], s28 offen offset:0
    buffer_load_dwordx4 a[20:23], v5, s[12:15], s28 offen offset:1024
    buffer_load_dwordx4 a[24:27], v5, s[12:15], s28 offen offset:2048
    buffer_load_dwordx4 a[28:31], v5, s[12:15], s28 offen offset:3072
    s_waitcnt vmcnt(8)
    s_barrier
    ds_read_b128 v[36:39], v5 offset:0
    ds_read_b128 v[40:43], v5 offset:1024
    ds_read_b128 v[44:47], v5 offset:2048
    ds_read_b128 v[48:51], v5 offset:3072
    ds_read_b128 v[52:55], v5 offset:4096
    ds_read_b128 v[56:59], v5 offset:5120
    s_waitcnt lgkmcnt(4)
    v_mfma_f32_16x16x32_bf16 v[20:23], a[128:131], v[36:39], 0
    v_mfma_f32_16x16x32_bf16 v[24:27], a[132:135], v[36:39], 0
    v_mfma_f32_16x16x32_bf16 v[28:31], a[128:131], v[40:43], 0
    v_mfma_f32_16x16x32_bf16 v[32:35], a[132:135], v[40:43], 0
    s_add_u32 s28, s28, 4096
    buffer_load_dwordx4 a[32:35], v5, s[12:15], s28 offen offset:0
    ds_read_b128 v[60:63], v5 offset:6144
    ds_read_b128 v[64:67], v5 offset:7168
    s_waitcnt lgkmcnt(4)
    v_mfma_f32_16x16x32_bf16 v[20:23], a[136:139], v[44:47], v[20:23]
    v_mfma_f32_16x16x32_bf16 v[24:27], a[140:143], v[44:47], v[24:27]
    v_mfma_f32_16x16x32_bf16 v[28:31], a[136:139], v[48:51], v[28:31]
    v_mfma_f32_16x16x32_bf16 v[32:35], a[140:143], v[48:51], v[32:35]
    buffer_load_dwordx4 a[36:39], v5, s[12:15], s28 offen offset:1024
    ds_read_b128 v[36:39], v5 offset:8192
    ds_read_b128 v[40:43], v5 offset:9216
    s_waitcnt lgkmcnt(4)
    v_mfma_f32_16x16x32_bf16 v[20:23], a[144:147], v[52:55], v[20:23]
    v_mfma_f32_16x16x32_bf16 v[24:27], a[148:151], v[52:55], v[24:27]
    v_mfma_f32_16x16x32_bf16 v[28:31], a[144:147], v[56:59], v[28:31]
    v_mfma_f32_16x16x32_bf16 v[32:35], a[148:151], v[56:59], v[32:35]
    buffer_load_dwordx4 a[40:43], v5, s[12:15], s28 offen offset:2048
    ds_read_b128 v[44:47], v5 offset:10240
    ds_read_b128 v[48:51], v5 offset:11264
    s_waitcnt lgkmcnt(4)
    v_mfma_f32_16x16x32_bf16 v[20:23], a[152:155], v[60:63], v[20:23]
    v_mfma_f32_16x16x32_bf16 v[24:27], a[156:159], v[60:63], v[24:27]
    v_mfma_f32_16x16x32_bf16 v[28:31], a[152:155], v[64:67], v[28:31]
    v_mfma_f32_16x16x32_bf16 v[32:35], a[156:159], v[64:67], v[32:35]
    buffer_load_dwordx4 a[44:47], v5, s[12:15], s28 offen offset:3072
    ds_read_b128 v[52:55], v5 offset:12288
    ds_read_b128 v[56:59], v5 offset:13312
    s_waitcnt lgkmcnt(4)
    v_mfma_f32_16x16x32_bf16 v[20:23], a[160:163], v[36:39], v[20:23]
    v_mfma_f32_16x16x32_bf16 v[24:27], a[164:167], v[36:39], v[24:27]
    v_mfma_f32_16x16x32_bf16 v[28:31], a[160:163], v[40:43], v[28:31]
    v_mfma_f32_16x16x32_bf16 v[32:35], a[164:167], v[40:43], v[32:35]
    s_add_u32 s28, s28, 4096
    buffer_load_dwordx4 a[48:51], v5, s[12:15], s28 offen offset:0
    ds_read_b128 v[60:63], v5 offset:14336
    ds_read_b128 v[64:67], v5 offset:15360
    s_waitcnt lgkmcnt(4)
    v_mfma_f32_16x16x32_bf16 v[20:23], a[168:171], v[44:47], v[20:23]
    v_mfma_f32_16x16x32_bf16 v[24:27], a[172:175], v[44:47], v[24:27]
    v_mfma_f32_16x16x32_bf16 v[28:31], a[168:171], v[48:51], v[28:31]
    v_mfma_f32_16x16x32_bf16 v[32:35], a[172:175], v[48:51], v[32:35]
    buffer_load_dwordx4 a[52:55], v5, s[12:15], s28 offen offset:1024
    ds_read_b128 v[36:39], v5 offset:16384
    ds_read_b128 v[40:43], v5 offset:17408
    s_waitcnt lgkmcnt(4)
    v_mfma_f32_16x16x32_bf16 v[20:23], a[176:179], v[52:55], v[20:23]
    v_mfma_f32_16x16x32_bf16 v[24:27], a[180:183], v[52:55], v[24:27]
    v_mfma_f32_16x16x32_bf16 v[28:31], a[176:179], v[56:59], v[28:31]
    v_mfma_f32_16x16x32_bf16 v[32:35], a[180:183], v[56:59], v[32:35]
    buffer_load_dwordx4 a[56:59], v5, s[12:15], s28 offen offset:2048
    ds_read_b128 v[44:47], v5 offset:18432
    ds_read_b128 v[48:51], v5 offset:19456
    s_waitcnt lgkmcnt(4)
    v_mfma_f32_16x16x32_bf16 v[20:23], a[184:187], v[60:63], v[20:23]
    v_mfma_f32_16x16x32_bf16 v[24:27], a[188:191], v[60:63], v[24:27]
    v_mfma_f32_16x16x32_bf16 v[28:31], a[184:187], v[64:67], v[28:31]
    v_mfma_f32_16x16x32_bf16 v[32:35], a[188:191], v[64:67], v[32:35]
    buffer_load_dwordx4 a[60:63], v5, s[12:15], s28 offen offset:3072
    ds_read_b128 v[52:55], v5 offset:20480
    ds_read_b128 v[56:59], v5 offset:21504
    s_waitcnt lgkmcnt(4)
    v_mfma_f32_16x16x32_bf16 v[20:23], a[192:195], v[36:39], v[20:23]
    v_mfma_f32_16x16x32_bf16 v[24:27], a[196:199], v[36:39], v[24:27]
    v_mfma_f32_16x16x32_bf16 v[28:31], a[192:195], v[40:43], v[28:31]
    v_mfma_f32_16x16x32_bf16 v[32:35], a[196:199], v[40:43], v[32:35]
    s_add_u32 s28, s28, 4096
    buffer_load_dwordx4 a[64:67], v5, s[12:15], s28 offen offset:0
    ds_read_b128 v[60:63], v5 offset:22528
    ds_read_b128 v[64:67], v5 offset:23552
    s_waitcnt lgkmcnt(4)
    v_mfma_f32_16x16x32_bf16 v[20:23], a[200:203], v[44:47], v[20:23]
    v_mfma_f32_16x16x32_bf16 v[24:27], a[204:207], v[44:47], v[24:27]
    v_mfma_f32_16x16x32_bf16 v[28:31], a[200:203], v[48:51], v[28:31]
    v_mfma_f32_16x16x32_bf16 v[32:35], a[204:207], v[48:51], v[32:35]
    buffer_load_dwordx4 a[68:71], v5, s[12:15], s28 offen offset:1024
    ds_read_b128 v[36:39], v5 offset:24576
    ds_read_b128 v[40:43], v5 offset:25600
    s_waitcnt lgkmcnt(4)
    v_mfma_f32_16x16x32_bf16 v[20:23], a[208:211], v[52:55], v[20:23]
    v_mfma_f32_16x16x32_bf16 v[24:27], a[212:215], v[52:55], v[24:27]
    v_mfma_f32_16x16x32_bf16 v[28:31], a[208:211], v[56:59], v[28:31]
    v_mfma_f32_16x16x32_bf16 v[32:35], a[212:215], v[56:59], v[32:35]
    buffer_load_dwordx4 a[72:75], v5, s[12:15], s28 offen offset:2048
    ds_read_b128 v[44:47], v5 offset:26624
    ds_read_b128 v[48:51], v5 offset:27648
    s_waitcnt lgkmcnt(4)
    v_mfma_f32_16x16x32_bf16 v[20:23], a[216:219], v[60:63], v[20:23]
    v_mfma_f32_16x16x32_bf16 v[24:27], a[220:223], v[60:63], v[24:27]
    v_mfma_f32_16x16x32_bf16 v[28:31], a[216:219], v[64:67], v[28:31]
    v_mfma_f32_16x16x32_bf16 v[32:35], a[220:223], v[64:67], v[32:35]
    buffer_load_dwordx4 a[76:79], v5, s[12:15], s28 offen offset:3072
    ds_read_b128 v[52:55], v5 offset:28672
    ds_read_b128 v[56:59], v5 offset:29696
    s_waitcnt lgkmcnt(4)
    v_mfma_f32_16x16x32_bf16 v[20:23], a[224:227], v[36:39], v[20:23]
    v_mfma_f32_16x16x32_bf16 v[24:27], a[228:231], v[36:39], v[24:27]
    v_mfma_f32_16x16x32_bf16 v[28:31], a[224:227], v[40:43], v[28:31]
    v_mfma_f32_16x16x32_bf16 v[32:35], a[228:231], v[40:43], v[32:35]
    s_add_u32 s28, s28, 4096
    buffer_load_dwordx4 a[80:83], v5, s[12:15], s28 offen offset:0
    ds_read_b128 v[60:63], v5 offset:30720
    ds_read_b128 v[64:67], v5 offset:31744
    s_waitcnt lgkmcnt(4)
    v_mfma_f32_16x16x32_bf16 v[20:23], a[232:235], v[44:47], v[20:23]
    v_mfma_f32_16x16x32_bf16 v[24:27], a[236:239], v[44:47], v[24:27]
    v_mfma_f32_16x16x32_bf16 v[28:31], a[232:235], v[48:51], v[28:31]
    v_mfma_f32_16x16x32_bf16 v[32:35], a[236:239], v[48:51], v[32:35]
    buffer_load_dwordx4 a[84:87], v5, s[12:15], s28 offen offset:1024
    s_waitcnt lgkmcnt(2)
    v_mfma_f32_16x16x32_bf16 v[20:23], a[240:243], v[52:55], v[20:23]
    v_mfma_f32_16x16x32_bf16 v[24:27], a[244:247], v[52:55], v[24:27]
    v_mfma_f32_16x16x32_bf16 v[28:31], a[240:243], v[56:59], v[28:31]
    v_mfma_f32_16x16x32_bf16 v[32:35], a[244:247], v[56:59], v[32:35]
    buffer_load_dwordx4 a[88:91], v5, s[12:15], s28 offen offset:2048
    s_waitcnt lgkmcnt(0)
    v_mfma_f32_16x16x32_bf16 v[20:23], a[248:251], v[60:63], v[20:23]
    v_mfma_f32_16x16x32_bf16 v[24:27], a[252:255], v[60:63], v[24:27]
    v_mfma_f32_16x16x32_bf16 v[28:31], a[248:251], v[64:67], v[28:31]
    v_mfma_f32_16x16x32_bf16 v[32:35], a[252:255], v[64:67], v[32:35]
    buffer_load_dwordx4 a[92:95], v5, s[12:15], s28 offen offset:3072
    v_lshlrev_b32 v36, 16, v12
    v_and_b32 v37, 0xffff0000, v12
    v_lshlrev_b32 v38, 16, v13
    v_and_b32 v39, 0xffff0000, v13
    s_add_u32 s28, s28, 4096
    buffer_load_dwordx4 a[96:99], v5, s[12:15], s28 offen offset:0
    v_lshlrev_b32 v40, 16, v14
    v_and_b32 v41, 0xffff0000, v14
    v_lshlrev_b32 v42, 16, v15
    v_and_b32 v43, 0xffff0000, v15
    buffer_load_dwordx4 a[100:103], v5, s[12:15], s28 offen offset:1024
    v_lshlrev_b32 v44, 16, v16
    v_and_b32 v45, 0xffff0000, v16
    v_lshlrev_b32 v46, 16, v17
    v_and_b32 v47, 0xffff0000, v17
    buffer_load_dwordx4 a[104:107], v5, s[12:15], s28 offen offset:2048
    v_lshlrev_b32 v48, 16, v18
    v_and_b32 v49, 0xffff0000, v18
    v_lshlrev_b32 v50, 16, v19
    v_and_b32 v51, 0xffff0000, v19
    buffer_load_dwordx4 a[108:111], v5, s[12:15], s28 offen offset:3072
    v_pk_add_f32 v[20:21], v[20:21], v[36:37]
    v_pk_add_f32 v[22:23], v[22:23], v[38:39]
    v_pk_add_f32 v[24:25], v[24:25], v[40:41]
    v_pk_add_f32 v[26:27], v[26:27], v[42:43]
    v_pk_add_f32 v[28:29], v[28:29], v[44:45]
    v_pk_add_f32 v[30:31], v[30:31], v[46:47]
    v_pk_add_f32 v[32:33], v[32:33], v[48:49]
    v_pk_add_f32 v[34:35], v[34:35], v[50:51]
    v_cvt_pk_bf16_f32 v60, v20, v21
    v_cvt_pk_bf16_f32 v61, v22, v23
    v_cvt_pk_bf16_f32 v62, v24, v25
    v_cvt_pk_bf16_f32 v63, v26, v27
    buffer_store_dwordx4 v[60:63], v5, s[64:67], s60 offen offset:0 sc1
    v_cvt_pk_bf16_f32 v64, v28, v29
    v_cvt_pk_bf16_f32 v65, v30, v31
    v_cvt_pk_bf16_f32 v66, v32, v33
    v_cvt_pk_bf16_f32 v67, v34, v35
    buffer_store_dwordx4 v[64:67], v5, s[64:67], s60 offen offset:1024 sc1
    s_add_u32 s28, s28, 4096
    buffer_load_dwordx4 a[112:115], v5, s[12:15], s28 offen offset:0
    buffer_load_dwordx4 a[116:119], v5, s[12:15], s28 offen offset:1024
    v_pk_add_f32 v[52:53], v[20:21], v[22:23]
    v_pk_mul_f32 v[54:55], v[20:21], v[20:21]
    v_pk_add_f32 v[52:53], v[52:53], v[24:25]
    v_pk_fma_f32 v[54:55], v[22:23], v[22:23], v[54:55]
    v_pk_add_f32 v[52:53], v[52:53], v[26:27]
    v_pk_fma_f32 v[54:55], v[24:25], v[24:25], v[54:55]
    v_pk_fma_f32 v[54:55], v[26:27], v[26:27], v[54:55]
    buffer_load_dwordx4 a[120:123], v5, s[12:15], s28 offen offset:2048
    buffer_load_dwordx4 a[124:127], v5, s[12:15], s28 offen offset:3072
    v_pk_add_f32 v[56:57], v[28:29], v[30:31]
    v_pk_mul_f32 v[58:59], v[28:29], v[28:29]
    v_pk_add_f32 v[56:57], v[56:57], v[32:33]
    v_pk_fma_f32 v[58:59], v[30:31], v[30:31], v[58:59]
    v_pk_add_f32 v[56:57], v[56:57], v[34:35]
    v_pk_fma_f32 v[58:59], v[32:33], v[32:33], v[58:59]
    v_pk_fma_f32 v[58:59], v[34:35], v[34:35], v[58:59]
    v_add_f32 v52, v52, v53
    v_add_f32 v53, v54, v55
    v_add_f32 v56, v56, v57
    v_add_f32 v57, v58, v59
    v_mov_b32 v68, v52
    v_mov_b32 v69, v53
    v_mov_b32 v70, v56
    v_mov_b32 v71, v57
    v_permlane16_swap_b32 v52, v68
    v_permlane16_swap_b32 v53, v69
    v_permlane16_swap_b32 v56, v70
    v_permlane16_swap_b32 v57, v71
    v_add_f32 v52, v52, v68
    v_add_f32 v53, v53, v69
    v_add_f32 v56, v56, v70
    v_add_f32 v57, v57, v71
    v_mov_b32 v68, v52
    v_mov_b32 v69, v53
    v_mov_b32 v70, v56
    v_mov_b32 v71, v57
    v_permlane32_swap_b32 v52, v68
    v_permlane32_swap_b32 v53, v69
    v_permlane32_swap_b32 v56, v70
    v_permlane32_swap_b32 v57, v71
    v_add_f32 v52, v52, v68
    v_add_f32 v53, v53, v69
    v_add_f32 v56, v56, v70
    v_add_f32 v57, v57, v71
    s_lshl_b32 s44, s42, 8
    s_add_u32 s44, s44, 69632
    v_lshl_add_u32 v6, v3, 3, s44
    ds_write_b64 v6, v[52:53]
    ds_write_b64 v6, v[56:57] offset:128
    s_waitcnt lgkmcnt(0)
    s_barrier
    s_cmp_eq_u32 s42, 0
    s_cbranch_scc0 .Lmlp_ke_dend_10
    v_and_b32 v6, 31, v2
    v_lshlrev_b32 v7, 3, v6
    v_add_u32 v7, 69632, v7
    ds_read_b64 v[36:37], v7 offset:0
    ds_read_b64 v[38:39], v7 offset:256
    ds_read_b64 v[40:41], v7 offset:512
    ds_read_b64 v[42:43], v7 offset:768
    v_add_u32 v6, s94, v6
    v_lshlrev_b32 v6, 5, v6
    v_mov_b32 v7, 0x7ff00000
    v_cmp_gt_u32 vcc, 32, v2
    s_nop 1
    v_cndmask_b32 v6, v7, v6, vcc
    s_lshl_b32 s44, s93, 3
    s_waitcnt lgkmcnt(0)
    v_pk_add_f32 v[36:37], v[36:37], v[38:39]
    v_pk_add_f32 v[40:41], v[40:41], v[42:43]
    v_pk_add_f32 v[36:37], v[36:37], v[40:41]
    buffer_store_dwordx2 v[36:37], v6, s[68:71], s44 offen sc1
.Lmlp_ke_dend_10:
    s_waitcnt vmcnt(0)
    s_barrier
    s_cmp_eq_u32 s42, 0
    s_cbranch_scc0 .Lmlp_ke_pub_11
    s_lshr_b32 s44, s25, 2
    s_lshl_b32 s44, s44, 6
    s_and_b32 s45, s25, 3
    s_lshl_b32 s45, s45, 2
    s_add_u32 s44, s44, s45
    s_add_u32 s44, s44, 16384
    v_mov_b32 v6, s24
    v_mov_b32 v7, 0x7ff00000
    v_cmp_eq_u32 vcc, 0, v2
    s_nop 1
    v_cndmask_b32 v7, v7, v2, vcc
    buffer_store_dword v6, v7, s[20:23], s44 offen sc1
.Lmlp_ke_pub_11:
    s_add_u32 s48, s40, 0xf00000
    s_addc_u32 s49, s41, 0
    s_mov_b32 s50, 0x200000
    s_mov_b32 s51, 0x20000
    s_add_u32 s52, s40, 0x1c10000
    s_addc_u32 s53, s41, 0
    s_mov_b32 s54, 0x10000
    s_mov_b32 s55, 0x20000
    s_add_u32 s64, s40, 0x1c08000
    s_addc_u32 s65, s41, 0
    s_mov_b32 s66, 0x2c00
    s_mov_b32 s67, 0x20000
    s_mul_i32 s44, s90, 176128
    s_add_u32 s44, s44, 0x1100000
    s_add_u32 s68, s40, s44
    s_addc_u32 s69, s41, 0
    s_mov_b32 s70, 0x2b000
    s_mov_b32 s71, 0x20000
    s_lshl_b32 s47, s91, 2
    s_add_u32 s47, s47, s42
    s_mul_i32 s44, s47, 192
    v_lshlrev_b32 v6, 4, v4
    buffer_load_dwordx4 v[48:51], v6, s[64:67], s44 offen offset:0 sc1
    buffer_load_dwordx4 v[52:55], v6, s[64:67], s44 offen offset:64 sc1
    buffer_load_dwordx4 v[56:59], v6, s[64:67], s44 offen offset:128 sc1
    s_add_u32 s44, s44, 5632
    buffer_load_dwordx4 v[60:63], v6, s[64:67], s44 offen offset:0 sc1
    buffer_load_dwordx4 v[64:67], v6, s[64:67], s44 offen offset:64 sc1
    buffer_load_dwordx4 v[68:71], v6, s[64:67], s44 offen offset:128 sc1
    s_add_u32 s28, s28, 4096
    buffer_load_dwordx4 a[128:131], v5, s[12:15], s28 offen offset:0
    buffer_load_dwordx4 a[132:135], v5, s[12:15], s28 offen offset:1024
    buffer_load_dwordx4 a[136:139], v5, s[12:15], s28 offen offset:2048
    buffer_load_dwordx4 a[140:143], v5, s[12:15], s28 offen offset:3072
    s_add_u32 s28, s28, 4096
    buffer_load_dwordx4 a[144:147], v5, s[12:15], s28 offen offset:0
    buffer_load_dwordx4 a[148:151], v5, s[12:15], s28 offen offset:1024
    buffer_load_dwordx4 a[152:155], v5, s[12:15], s28 offen offset:2048
    buffer_load_dwordx4 a[156:159], v5, s[12:15], s28 offen offset:3072
    v_lshrrev_b32 v6, 1, v4
    v_lshlrev_b32 v9, 8, v6
    v_lshl_add_u32 v9, v3, 4, v9
    v_and_b32 v6, 1, v4
    v_lshl_add_u32 v9, v6, 3, v9
    s_mul_i32 s44, s47, 3
    s_add_u32 s44, s44, 0
    s_lshr_b32 s61, s44, 1
    s_lshl_b32 s61, s61, 12
    s_and_b32 s44, s44, 1
    s_lshl_b32 s44, s44, 9
    s_add_u32 s61, s61, s44
    s_mul_i32 s44, s47, 3
    s_add_u32 s44, s44, 1
    s_lshr_b32 s62, s44, 1
    s_lshl_b32 s62, s62, 12
    s_and_b32 s44, s44, 1
    s_lshl_b32 s44, s44, 9
    s_add_u32 s62, s62, s44
    s_mul_i32 s44, s47, 3
    s_add_u32 s44, s44, 2
    s_lshr_b32 s63, s44, 1
    s_lshl_b32 s63, s63, 12
    s_and_b32 s44, s44, 1
    s_lshl_b32 s44, s44, 9
    s_add_u32 s63, s63, s44
    s_lshl_b32 s43, s90, 3
    s_cmp_eq_u32 s42, 0
    s_cbranch_scc0 .Lmlp_ke_aw_12
    s_ashr_i32 s44, s43, 2
    s_add_i32 s45, s44, 0
    s_max_i32 s45, s45, 0
    s_min_i32 s45, s45, 63
    s_lshl_b32 s45, s45, 6
    s_add_u32 s45, s45, 0x1d04000
    s_add_u32 s80, s40, s45
    s_addc_u32 s81, s41, 0
    s_add_i32 s45, s44, 1
    s_max_i32 s45, s45, 0
    s_min_i32 s45, s45, 63
    s_lshl_b32 s45, s45, 6
    s_add_u32 s45, s45, 0x1d04000
    s_add_u32 s82, s40, s45
    s_addc_u32 s83, s41, 0
    s_mov_b32 s44, 0
.Lmlp_ke_poll_13:
    s_load_dwordx4 s[4:7], s[80:81], 0 glc
    s_load_dwordx4 s[96:99], s[82:83], 0 glc
    s_waitcnt lgkmcnt(0)
    s_and_b32 s4, s4, s5
    s_and_b32 s6, s6, s7
    s_and_b32 s4, s4, s6
    s_and_b32 s96, s96, s97
    s_and_b32 s98, s98, s99
    s_and_b32 s96, s96, s98
    s_and_b32 s4, s4, s96
    s_cmp_eq_u32 s4, s24
    s_cbranch_scc1 .Lmlp_ke_pout_14
    s_add_u32 s44, s44, 1
    s_cmp_lt_u32 s44, 0x40000
    s_cbranch_scc1 .Lmlp_ke_poll_13
.Lmlp_ke_pout_14:
.Lmlp_ke_aw_12:
    s_barrier
    v_add_u32 v6, s95, v3
    v_lshlrev_b32 v6, 5, v6
    buffer_load_dwordx4 v[16:19], v6, s[52:55], 0 offen offset:0 sc1
    buffer_load_dwordx4 v[20:23], v6, s[52:55], 0 offen offset:16 sc1
    buffer_load_dwordx4 v[24:27], v6, s[52:55], 0 offen offset:512 sc1
    buffer_load_dwordx4 v[28:31], v6, s[52:55], 0 offen offset:528 sc1
    buffer_load_dwordx4 v[32:35], v6, s[52:55], 0 offen offset:1024 sc1
    buffer_load_dwordx4 v[36:39], v6, s[52:55], 0 offen offset:1040 sc1
    buffer_load_dwordx4 v[40:43], v6, s[52:55], 0 offen offset:1536 sc1
    buffer_load_dwordx4 v[44:47], v6, s[52:55], 0 offen offset:1552 sc1
    s_lshl_b32 s46, s42, 14
    s_lshl_b32 s72, s90, 16
    s_add_u32 s72, s72, s46
    s_add_u32 m0, s46, 0
    s_add_u32 s44, s72, 0
    buffer_load_dwordx4 v5, s[48:51], s44 offen sc1 lds
    s_add_u32 m0, s46, 4096
    s_add_u32 s44, s72, 4096
    buffer_load_dwordx4 v5, s[48:51], s44 offen sc1 lds
    s_add_u32 m0, s46, 8192
    s_add_u32 s44, s72, 8192
    buffer_load_dwordx4 v5, s[48:51], s44 offen sc1 lds
    s_add_u32 m0, s46, 12288
    s_add_u32 s44, s72, 12288
    buffer_load_dwordx4 v5, s[48:51], s44 offen sc1 lds
    s_add_u32 s28, s28, 4096
    buffer_load_dwordx4 a[160:163], v5, s[12:15], s28 offen offset:0
    buffer_load_dwordx4 a[164:167], v5, s[12:15], s28 offen offset:1024
    buffer_load_dwordx4 a[168:171], v5, s[12:15], s28 offen offset:2048
    buffer_load_dwordx4 a[172:175], v5, s[12:15], s28 offen offset:3072
    s_add_u32 s28, s28, 4096
    buffer_load_dwordx4 a[176:179], v5, s[12:15], s28 offen offset:0
    buffer_load_dwordx4 a[180:183], v5, s[12:15], s28 offen offset:1024
    buffer_load_dwordx4 a[184:187], v5, s[12:15], s28 offen offset:2048
    buffer_load_dwordx4 a[188:191], v5, s[12:15], s28 offen offset:3072
    s_waitcnt vmcnt(8)
    s_barrier
    ds_read_b128 v[120:123], v5 offset:0
    ds_read_b128 v[124:127], v5 offset:4096
    ds_read_b128 v[128:131], v5 offset:8192
    ds_read_b128 v[132:135], v5 offset:12288
    s_waitcnt lgkmcnt(3)
    v_mfma_f32_16x16x32_bf16 v[96:99], a[0:3], v[120:123], 0
    v_mfma_f32_16x16x32_bf16 v[100:103], a[64:67], v[120:123], 0
    v_mfma_f32_16x16x32_bf16 v[104:107], a[128:131], v[120:123], 0
    s_add_u32 m0, s46, 1024
    s_add_u32 s44, s72, 1024
    buffer_load_dwordx4 v5, s[48:51], s44 offen sc1 lds
    ds_read_b128 v[120:123], v5 offset:16384
    s_waitcnt lgkmcnt(3)
    v_mfma_f32_16x16x32_bf16 v[96:99], a[4:7], v[124:127], v[96:99]
    v_mfma_f32_16x16x32_bf16 v[100:103], a[68:71], v[124:127], v[100:103]
    v_mfma_f32_16x16x32_bf16 v[104:107], a[132:135], v[124:127], v[104:107]
    s_add_u32 m0, s46, 5120
    s_add_u32 s44, s72, 5120
    buffer_load_dwordx4 v5, s[48:51], s44 offen sc1 lds
    ds_read_b128 v[124:127], v5 offset:20480
    s_waitcnt lgkmcnt(3)
    v_mfma_f32_16x16x32_bf16 v[96:99], a[8:11], v[128:131], v[96:99]
    v_mfma_f32_16x16x32_bf16 v[100:103], a[72:75], v[128:131], v[100:103]
    v_mfma_f32_16x16x32_bf16 v[104:107], a[136:139], v[128:131], v[104:107]
    s_add_u32 m0, s46, 9216
    s_add_u32 s44, s72, 9216
    buffer_load_dwordx4 v5, s[48:51], s44 offen sc1 lds
    ds_read_b128 v[128:131], v5 offset:24576
    s_waitcnt lgkmcnt(3)
    v_mfma_f32_16x16x32_bf16 v[96:99], a[12:15], v[132:135], v[96:99]
    v_mfma_f32_16x16x32_bf16 v[100:103], a[76:79], v[132:135], v[100:103]
    v_mfma_f32_16x16x32_bf16 v[104:107], a[140:143], v[132:135], v[104:107]
    s_add_u32 m0, s46, 13312
    s_add_u32 s44, s72, 13312
    buffer_load_dwordx4 v5, s[48:51], s44 offen sc1 lds
    ds_read_b128 v[132:135], v5 offset:28672
    s_waitcnt lgkmcnt(3)
    v_mfma_f32_16x16x32_bf16 v[96:99], a[16:19], v[120:123], v[96:99]
    v_add_f32 v48, v48, v60
    v_add_f32 v49, v49, v61
    v_add_f32 v50, v50, v62
    v_mfma_f32_16x16x32_bf16 v[100:103], a[80:83], v[120:123], v[100:103]
    v_add_f32 v51, v51, v63
    v_add_f32 v52, v52, v64
    v_add_f32 v53, v53, v65
    v_mfma_f32_16x16x32_bf16 v[104:107], a[144:147], v[120:123], v[104:107]
    v_add_f32 v54, v54, v66
    v_add_f32 v55, v55, v67
    v_add_f32 v56, v56, v68
    s_add_u32 m0, s46, 2048
    s_add_u32 s44, s72, 2048
    buffer_load_dwordx4 v5, s[48:51], s44 offen sc1 lds
    ds_read_b128 v[120:123], v5 offset:32768
    s_waitcnt lgkmcnt(3)
    v_mfma_f32_16x16x32_bf16 v[96:99], a[20:23], v[124:127], v[96:99]
    v_add_f32 v57, v57, v69
    v_add_f32 v58, v58, v70
    v_add_f32 v59, v59, v71
    v_mfma_f32_16x16x32_bf16 v[100:103], a[84:87], v[124:127], v[100:103]
    v_add_f32 v16, v16, v18
    v_add_f32 v17, v17, v19
    v_add_f32 v20, v20, v22
    v_mfma_f32_16x16x32_bf16 v[104:107], a[148:151], v[124:127], v[104:107]
    v_add_f32 v21, v21, v23
    v_add_f32 v24, v24, v26
    v_add_f32 v25, v25, v27
    s_add_u32 m0, s46, 6144
    s_add_u32 s44, s72, 6144
    buffer_load_dwordx4 v5, s[48:51], s44 offen sc1 lds
    ds_read_b128 v[124:127], v5 offset:36864
    s_waitcnt lgkmcnt(3)
    v_mfma_f32_16x16x32_bf16 v[96:99], a[24:27], v[128:131], v[96:99]
    v_add_f32 v28, v28, v30
    v_add_f32 v29, v29, v31
    v_add_f32 v32, v32, v34
    v_mfma_f32_16x16x32_bf16 v[100:103], a[88:91], v[128:131], v[100:103]
    v_add_f32 v33, v33, v35
    v_add_f32 v36, v36, v38
    v_add_f32 v37, v37, v39
    v_mfma_f32_16x16x32_bf16 v[104:107], a[152:155], v[128:131], v[104:107]
    v_add_f32 v40, v40, v42
    v_add_f32 v41, v41, v43
    v_add_f32 v44, v44, v46
    s_add_u32 m0, s46, 10240
    s_add_u32 s44, s72, 10240
    buffer_load_dwordx4 v5, s[48:51], s44 offen sc1 lds
    ds_read_b128 v[128:131], v5 offset:40960
    s_waitcnt lgkmcnt(3)
    v_mfma_f32_16x16x32_bf16 v[96:99], a[28:31], v[132:135], v[96:99]
    v_add_f32 v45, v45, v47
    v_add_f32 v16, v16, v20
    v_add_f32 v17, v17, v21
    v_mfma_f32_16x16x32_bf16 v[100:103], a[92:95], v[132:135], v[100:103]
    v_add_f32 v24, v24, v28
    v_add_f32 v25, v25, v29
    v_add_f32 v32, v32, v36
    v_mfma_f32_16x16x32_bf16 v[104:107], a[156:159], v[132:135], v[104:107]
    v_add_f32 v33, v33, v37
    v_add_f32 v40, v40, v44
    v_add_f32 v41, v41, v45
    s_add_u32 m0, s46, 14336
    s_add_u32 s44, s72, 14336
    buffer_load_dwordx4 v5, s[48:51], s44 offen sc1 lds
    ds_read_b128 v[132:135], v5 offset:45056
    s_waitcnt lgkmcnt(3)
    s_waitcnt vmcnt(15)
    v_mfma_f32_16x16x32_bf16 v[96:99], a[32:35], v[120:123], v[96:99]
    v_mul_f32 v16, 0xbb000000, v16
    v_mul_f32 v24, 0xbb000000, v24
    v_mul_f32 v32, 0xbb000000, v32
    v_mfma_f32_16x16x32_bf16 v[100:103], a[96:99], v[120:123], v[100:103]
    v_mul_f32 v40, 0xbb000000, v40
    v_mul_f32 v17, 0x3b000000, v17
    v_mul_f32 v25, 0x3b000000, v25
    v_mfma_f32_16x16x32_bf16 v[104:107], a[160:163], v[120:123], v[104:107]
    v_mul_f32 v33, 0x3b000000, v33
    v_mul_f32 v41, 0x3b000000, v41
    v_mul_f32 v18, v16, v16
    s_add_u32 m0, s46, 3072
    s_add_u32 s44, s72, 3072
    buffer_load_dwordx4 v5, s[48:51], s44 offen sc1 lds
    ds_read_b128 v[120:123], v5 offset:49152
    s_waitcnt lgkmcnt(3)
    s_waitcnt vmcnt(15)
    v_mfma_f32_16x16x32_bf16 v[96:99], a[36:39], v[124:127], v[96:99]
    v_mul_f32 v26, v24, v24
    v_mul_f32 v34, v32, v32
    v_mul_f32 v42, v40, v40
    v_mfma_f32_16x16x32_bf16 v[100:103], a[100:103], v[124:127], v[100:103]
    v_sub_f32 v17, v17, v18
    v_sub_f32 v25, v25, v26
    v_sub_f32 v33, v33, v34
    v_mfma_f32_16x16x32_bf16 v[104:107], a[164:167], v[124:127], v[104:107]
    v_sub_f32 v41, v41, v42
    v_max_f32 v17, 0, v17
    v_max_f32 v25, 0, v25
    s_add_u32 m0, s46, 7168
    s_add_u32 s44, s72, 7168
    buffer_load_dwordx4 v5, s[48:51], s44 offen sc1 lds
    ds_read_b128 v[124:127], v5 offset:53248
    s_waitcnt lgkmcnt(3)
    s_waitcnt vmcnt(15)
    v_mfma_f32_16x16x32_bf16 v[96:99], a[40:43], v[128:131], v[96:99]
    v_max_f32 v33, 0, v33
    v_max_f32 v41, 0, v41
    v_add_f32 v17, 0x3727c5ac, v17
    v_mfma_f32_16x16x32_bf16 v[100:103], a[104:107], v[128:131], v[100:103]
    v_add_f32 v25, 0x3727c5ac, v25
    v_add_f32 v33, 0x3727c5ac, v33
    v_add_f32 v41, 0x3727c5ac, v41
    v_mfma_f32_16x16x32_bf16 v[104:107], a[168:171], v[128:131], v[104:107]
    v_rsq_f32 v18, v17
    v_rsq_f32 v26, v25
    v_rsq_f32 v34, v33
    s_add_u32 m0, s46, 11264
    s_add_u32 s44, s72, 11264
    buffer_load_dwordx4 v5, s[48:51], s44 offen sc1 lds
    ds_read_b128 v[128:131], v5 offset:57344
    s_waitcnt lgkmcnt(3)
    s_waitcnt vmcnt(15)
    v_mfma_f32_16x16x32_bf16 v[96:99], a[44:47], v[132:135], v[96:99]
    v_rsq_f32 v42, v41
    v_mov_b32 v64, v16
    v_mov_b32 v72, v24
    v_mfma_f32_16x16x32_bf16 v[100:103], a[108:111], v[132:135], v[100:103]
    v_mov_b32 v80, v32
    v_mov_b32 v88, v40
    v_mul_f32 v70, v17, v18
    v_mfma_f32_16x16x32_bf16 v[104:107], a[172:175], v[132:135], v[104:107]
    v_mul_f32 v78, v25, v26
    v_mul_f32 v86, v33, v34
    v_mul_f32 v94, v41, v42
    s_add_u32 m0, s46, 15360
    s_add_u32 s44, s72, 15360
    buffer_load_dwordx4 v5, s[48:51], s44 offen sc1 lds
    s_waitcnt vmcnt(8)
    s_barrier
    ds_read_b128 v[132:135], v5 offset:61440
    s_waitcnt lgkmcnt(3)
    v_mfma_f32_16x16x32_bf16 v[96:99], a[48:51], v[120:123], v[96:99]
    v_mul_f32 v66, 0xc0135761, v18
    v_mul_f32 v74, 0xc0135761, v26
    v_mul_f32 v82, 0xc0135761, v34
    v_mfma_f32_16x16x32_bf16 v[100:103], a[112:115], v[120:123], v[100:103]
    v_mul_f32 v90, 0xc0135761, v42
    v_mul_f32 v68, v18, v18
    v_mul_f32 v76, v26, v26
    v_mfma_f32_16x16x32_bf16 v[104:107], a[176:179], v[120:123], v[104:107]
    v_mul_f32 v84, v34, v34
    v_mul_f32 v92, v42, v42
    v_mul_f32 v68, v68, v18
    s_mov_b32 s29, 0
    buffer_load_dwordx4 a[192:195], v5, s[16:19], s29 offen offset:0
    ds_read_b128 v[120:123], v5 offset:1024
    s_waitcnt lgkmcnt(3)
    v_mfma_f32_16x16x32_bf16 v[96:99], a[52:55], v[124:127], v[96:99]
    v_mul_f32 v76, v76, v26
    v_mul_f32 v84, v84, v34
    v_mul_f32 v92, v92, v42
    v_mfma_f32_16x16x32_bf16 v[100:103], a[116:119], v[124:127], v[100:103]
    v_mul_f32 v68, 0xbdd2d3e8, v68
    v_mul_f32 v76, 0xbdd2d3e8, v76
    v_mul_f32 v84, 0xbdd2d3e8, v84
    v_mfma_f32_16x16x32_bf16 v[104:107], a[180:183], v[124:127], v[104:107]
    v_mul_f32 v92, 0xbdd2d3e8, v92
    buffer_load_dwordx4 a[196:199], v5, s[16:19], s29 offen offset:1024
    ds_read_b128 v[124:127], v5 offset:5120
    s_waitcnt lgkmcnt(3)
    v_mfma_f32_16x16x32_bf16 v[96:99], a[56:59], v[128:131], v[96:99]
    v_mfma_f32_16x16x32_bf16 v[100:103], a[120:123], v[128:131], v[100:103]
    v_mfma_f32_16x16x32_bf16 v[104:107], a[184:187], v[128:131], v[104:107]
    buffer_load_dwordx4 a[200:203], v5, s[16:19], s29 offen offset:2048
    ds_read_b128 v[128:131], v5 offset:9216
    s_waitcnt lgkmcnt(3)
    v_mfma_f32_16x16x32_bf16 v[96:99], a[60:63], v[132:135], v[96:99]
    v_mfma_f32_16x16x32_bf16 v[100:103], a[124:127], v[132:135], v[100:103]
    v_mfma_f32_16x16x32_bf16 v[104:107], a[188:191], v[132:135], v[104:107]
    buffer_load_dwordx4 a[204:207], v5, s[16:19], s29 offen offset:3072
    ds_read_b128 v[132:135], v5 offset:13312
    s_waitcnt lgkmcnt(3)
    v_mfma_f32_16x16x32_bf16 v[108:111], a[0:3], v[120:123], 0
    v_mfma_f32_16x16x32_bf16 v[112:115], a[64:67], v[120:123], 0
    v_mfma_f32_16x16x32_bf16 v[116:119], a[128:131], v[120:123], 0
    v_pk_fma_f32 v[96:97], v[48:49], v[64:65], v[96:97] op_sel_hi:[1,0,1]
    v_pk_fma_f32 v[98:99], v[50:51], v[64:65], v[98:99] op_sel_hi:[1,0,1]
    v_pk_fma_f32 v[100:101], v[52:53], v[64:65], v[100:101] op_sel_hi:[1,0,1]
    v_pk_fma_f32 v[102:103], v[54:55], v[64:65], v[102:103] op_sel_hi:[1,0,1]
    v_pk_fma_f32 v[104:105], v[56:57], v[64:65], v[104:105] op_sel_hi:[1,0,1]
    v_pk_fma_f32 v[106:107], v[58:59], v[64:65], v[106:107] op_sel_hi:[1,0,1]
    v_pk_mul_f32 v[16:17], v[96:97], v[96:97]
    v_pk_mul_f32 v[18:19], v[98:99], v[98:99]
    v_pk_mul_f32 v[20:21], v[100:101], v[100:101]
    v_pk_mul_f32 v[22:23], v[102:103], v[102:103]
    v_pk_mul_f32 v[24:25], v[104:105], v[104:105]
    v_pk_mul_f32 v[26:27], v[106:107], v[106:107]
    v_pk_fma_f32 v[16:17], v[16:17], v[68:69], v[66:67] op_sel_hi:[1,0,0]
    v_pk_fma_f32 v[18:19], v[18:19], v[68:69], v[66:67] op_sel_hi:[1,0,0]
    v_pk_fma_f32 v[20:21], v[20:21], v[68:69], v[66:67] op_sel_hi:[1,0,0]
    v_pk_fma_f32 v[22:23], v[22:23], v[68:69], v[66:67] op_sel_hi:[1,0,0]
    v_pk_fma_f32 v[24:25], v[24:25], v[68:69], v[66:67] op_sel_hi:[1,0,0]
    v_pk_fma_f32 v[26:27], v[26:27], v[68:69], v[66:67] op_sel_hi:[1,0,0]
    v_pk_mul_f32 v[16:17], v[16:17], v[96:97]
    v_pk_mul_f32 v[18:19], v[18:19], v[98:99]
    v_pk_mul_f32 v[20:21], v[20:21], v[100:101]
    v_pk_mul_f32 v[22:23], v[22:23], v[102:103]
    v_pk_mul_f32 v[24:25], v[24:25], v[104:105]
    v_pk_mul_f32 v[26:27], v[26:27], v[106:107]
    s_add_u32 s29, s29, 4096
    buffer_load_dwordx4 a[208:211], v5, s[16:19], s29 offen offset:0
    ds_read_b128 v[120:123], v5 offset:17408
    s_waitcnt lgkmcnt(3)
    v_mfma_f32_16x16x32_bf16 v[108:111], a[4:7], v[124:127], v[108:111]
    v_exp_f32 v16, v16
    v_mfma_f32_16x16x32_bf16 v[112:115], a[68:71], v[124:127], v[112:115]
    v_exp_f32 v17, v17
    v_mfma_f32_16x16x32_bf16 v[116:119], a[132:135], v[124:127], v[116:119]
    v_exp_f32 v18, v18
    buffer_load_dwordx4 a[212:215], v5, s[16:19], s29 offen offset:1024
    ds_read_b128 v[124:127], v5 offset:21504
    s_waitcnt lgkmcnt(3)
    v_mfma_f32_16x16x32_bf16 v[108:111], a[8:11], v[128:131], v[108:111]
    v_exp_f32 v19, v19
    v_mfma_f32_16x16x32_bf16 v[112:115], a[72:75], v[128:131], v[112:115]
    v_exp_f32 v20, v20
    v_mfma_f32_16x16x32_bf16 v[116:119], a[136:139], v[128:131], v[116:119]
    v_exp_f32 v21, v21
    buffer_load_dwordx4 a[216:219], v5, s[16:19], s29 offen offset:2048
    ds_read_b128 v[128:131], v5 offset:25600
    s_waitcnt lgkmcnt(3)
    v_mfma_f32_16x16x32_bf16 v[108:111], a[12:15], v[132:135], v[108:111]
    v_exp_f32 v22, v22
    v_mfma_f32_16x16x32_bf16 v[112:115], a[76:79], v[132:135], v[112:115]
    v_exp_f32 v23, v23
    v_mfma_f32_16x16x32_bf16 v[116:119], a[140:143], v[132:135], v[116:119]
    v_exp_f32 v24, v24
    buffer_load_dwordx4 a[220:223], v5, s[16:19], s29 offen offset:3072
    ds_read_b128 v[132:135], v5 offset:29696
    s_waitcnt lgkmcnt(3)
    v_mfma_f32_16x16x32_bf16 v[108:111], a[16:19], v[120:123], v[108:111]
    v_exp_f32 v25, v25
    v_mfma_f32_16x16x32_bf16 v[112:115], a[80:83], v[120:123], v[112:115]
    v_exp_f32 v26, v26
    v_mfma_f32_16x16x32_bf16 v[116:119], a[144:147], v[120:123], v[116:119]
    v_exp_f32 v27, v27
    s_add_u32 s29, s29, 4096
    buffer_load_dwordx4 a[224:227], v5, s[16:19], s29 offen offset:0
    ds_read_b128 v[120:123], v5 offset:33792
    s_waitcnt lgkmcnt(3)
    v_mfma_f32_16x16x32_bf16 v[108:111], a[20:23], v[124:127], v[108:111]
    v_fma_f32 v16, v16, v70, v70
    v_fma_f32 v17, v17, v70, v70
    v_mfma_f32_16x16x32_bf16 v[112:115], a[84:87], v[124:127], v[112:115]
    v_fma_f32 v18, v18, v70, v70
    v_fma_f32 v19, v19, v70, v70
    v_mfma_f32_16x16x32_bf16 v[116:119], a[148:151], v[124:127], v[116:119]
    v_fma_f32 v20, v20, v70, v70
    v_fma_f32 v21, v21, v70, v70
    buffer_load_dwordx4 a[228:231], v5, s[16:19], s29 offen offset:1024
    ds_read_b128 v[124:127], v5 offset:37888
    s_waitcnt lgkmcnt(3)
    v_mfma_f32_16x16x32_bf16 v[108:111], a[24:27], v[128:131], v[108:111]
    v_fma_f32 v22, v22, v70, v70
    v_fma_f32 v23, v23, v70, v70
    v_mfma_f32_16x16x32_bf16 v[112:115], a[88:91], v[128:131], v[112:115]
    v_fma_f32 v24, v24, v70, v70
    v_fma_f32 v25, v25, v70, v70
    v_mfma_f32_16x16x32_bf16 v[116:119], a[152:155], v[128:131], v[116:119]
    v_fma_f32 v26, v26, v70, v70
    v_fma_f32 v27, v27, v70, v70
    buffer_load_dwordx4 a[232:235], v5, s[16:19], s29 offen offset:2048
    ds_read_b128 v[128:131], v5 offset:41984
    s_waitcnt lgkmcnt(3)
    v_mfma_f32_16x16x32_bf16 v[108:111], a[28:31], v[132:135], v[108:111]
    v_rcp_f32 v16, v16
    v_mfma_f32_16x16x32_bf16 v[112:115], a[92:95], v[132:135], v[112:115]
    v_rcp_f32 v17, v17
    v_mfma_f32_16x16x32_bf16 v[116:119], a[156:159], v[132:135], v[116:119]
    v_rcp_f32 v18, v18
    buffer_load_dwordx4 a[236:239], v5, s[16:19], s29 offen offset:3072
    ds_read_b128 v[132:135], v5 offset:46080
    s_waitcnt lgkmcnt(3)
    v_mfma_f32_16x16x32_bf16 v[108:111], a[32:35], v[120:123], v[108:111]
    v_rcp_f32 v19, v19
    v_mfma_f32_16x16x32_bf16 v[112:115], a[96:99], v[120:123], v[112:115]
    v_rcp_f32 v20, v20
    v_mfma_f32_16x16x32_bf16 v[116:119], a[160:163], v[120:123], v[116:119]
    v_rcp_f32 v21, v21
    s_add_u32 s29, s29, 4096
    buffer_load_dwordx4 a[240:243], v5, s[16:19], s29 offen offset:0
    ds_read_b128 v[120:123], v5 offset:50176
    s_waitcnt lgkmcnt(3)
    v_mfma_f32_16x16x32_bf16 v[108:111], a[36:39], v[124:127], v[108:111]
    v_rcp_f32 v22, v22
    v_mfma_f32_16x16x32_bf16 v[112:115], a[100:103], v[124:127], v[112:115]
    v_rcp_f32 v23, v23
    v_mfma_f32_16x16x32_bf16 v[116:119], a[164:167], v[124:127], v[116:119]
    v_rcp_f32 v24, v24
    buffer_load_dwordx4 a[244:247], v5, s[16:19], s29 offen offset:1024
    ds_read_b128 v[124:127], v5 offset:54272
    s_waitcnt lgkmcnt(3)
    v_mfma_f32_16x16x32_bf16 v[108:111], a[40:43], v[128:131], v[108:111]
    v_rcp_f32 v25, v25
    v_mfma_f32_16x16x32_bf16 v[112:115], a[104:107], v[128:131], v[112:115]
    v_rcp_f32 v26, v26
    v_mfma_f32_16x16x32_bf16 v[116:119], a[168:171], v[128:131], v[116:119]
    v_rcp_f32 v27, v27
    buffer_load_dwordx4 a[248:251], v5, s[16:19], s29 offen offset:2048
    ds_read_b128 v[128:131], v5 offset:58368
    s_waitcnt lgkmcnt(3)
    v_mfma_f32_16x16x32_bf16 v[108:111], a[44:47], v[132:135], v[108:111]
    v_mul_f32 v96, v96, v16
    v_mul_f32 v97, v97, v17
    v_mfma_f32_16x16x32_bf16 v[112:115], a[108:111], v[132:135], v[112:115]
    v_mul_f32 v98, v98, v18
    v_mul_f32 v99, v99, v19
    v_mfma_f32_16x16x32_bf16 v[116:119], a[172:175], v[132:135], v[116:119]
    v_mul_f32 v100, v100, v20
    v_mul_f32 v101, v101, v21
    buffer_load_dwordx4 a[252:255], v5, s[16:19], s29 offen offset:3072
    s_waitcnt vmcnt(20)
    s_barrier
    ds_read_b128 v[132:135], v5 offset:62464
    s_waitcnt lgkmcnt(3)
    v_mfma_f32_16x16x32_bf16 v[108:111], a[48:51], v[120:123], v[108:111]
    v_mul_f32 v102, v102, v22
    v_mul_f32 v103, v103, v23
    v_mfma_f32_16x16x32_bf16 v[112:115], a[112:115], v[120:123], v[112:115]
    v_mul_f32 v104, v104, v24
    v_mul_f32 v105, v105, v25
    v_mfma_f32_16x16x32_bf16 v[116:119], a[176:179], v[120:123], v[116:119]
    v_mul_f32 v106, v106, v26
    v_mul_f32 v107, v107, v27
    s_add_u32 s29, s29, 4096
    buffer_load_dwordx4 v[144:147], v5, s[16:19], s29 offen offset:0
    ds_read_b128 v[120:123], v5 offset:2048
    s_waitcnt lgkmcnt(3)
    v_mfma_f32_16x16x32_bf16 v[108:111], a[52:55], v[124:127], v[108:111]
    v_cvt_pk_bf16_f32 v28, v96, v97
    v_cvt_pk_bf16_f32 v29, v98, v99
    v_mfma_f32_16x16x32_bf16 v[112:115], a[116:119], v[124:127], v[112:115]
    v_cvt_pk_bf16_f32 v30, v100, v101
    v_cvt_pk_bf16_f32 v31, v102, v103
    v_mfma_f32_16x16x32_bf16 v[116:119], a[180:183], v[124:127], v[116:119]
    v_cvt_pk_bf16_f32 v32, v104, v105
    v_cvt_pk_bf16_f32 v33, v106, v107
    buffer_load_dwordx4 v[148:151], v5, s[16:19], s29 offen offset:1024
    ds_read_b128 v[124:127], v5 offset:6144
    s_waitcnt lgkmcnt(3)
    v_mfma_f32_16x16x32_bf16 v[108:111], a[56:59], v[128:131], v[108:111]
    buffer_store_dwordx2 v[28:29], v9, s[68:71], s61 offen offset:0 sc1
    buffer_store_dwordx2 v[30:31], v9, s[68:71], s62 offen offset:0 sc1
    v_mfma_f32_16x16x32_bf16 v[112:115], a[120:123], v[128:131], v[112:115]
    buffer_store_dwordx2 v[32:33], v9, s[68:71], s63 offen offset:0 sc1
    v_mfma_f32_16x16x32_bf16 v[116:119], a[184:187], v[128:131], v[116:119]
    buffer_load_dwordx4 v[152:155], v5, s[16:19], s29 offen offset:2048
    ds_read_b128 v[128:131], v5 offset:10240
    s_waitcnt lgkmcnt(3)
    v_mfma_f32_16x16x32_bf16 v[108:111], a[60:63], v[132:135], v[108:111]
    v_mfma_f32_16x16x32_bf16 v[112:115], a[124:127], v[132:135], v[112:115]
    v_mfma_f32_16x16x32_bf16 v[116:119], a[188:191], v[132:135], v[116:119]
    buffer_load_dwordx4 v[156:159], v5, s[16:19], s29 offen offset:3072
    ds_read_b128 v[132:135], v5 offset:14336
    s_waitcnt lgkmcnt(3)
    v_mfma_f32_16x16x32_bf16 v[96:99], a[0:3], v[120:123], 0
    v_mfma_f32_16x16x32_bf16 v[100:103], a[64:67], v[120:123], 0
    v_mfma_f32_16x16x32_bf16 v[104:107], a[128:131], v[120:123], 0
    v_pk_fma_f32 v[108:109], v[48:49], v[72:73], v[108:109] op_sel_hi:[1,0,1]
    v_pk_fma_f32 v[110:111], v[50:51], v[72:73], v[110:111] op_sel_hi:[1,0,1]
    v_pk_fma_f32 v[112:113], v[52:53], v[72:73], v[112:113] op_sel_hi:[1,0,1]
    v_pk_fma_f32 v[114:115], v[54:55], v[72:73], v[114:115] op_sel_hi:[1,0,1]
    v_pk_fma_f32 v[116:117], v[56:57], v[72:73], v[116:117] op_sel_hi:[1,0,1]
    v_pk_fma_f32 v[118:119], v[58:59], v[72:73], v[118:119] op_sel_hi:[1,0,1]
    v_pk_mul_f32 v[16:17], v[108:109], v[108:109]
    v_pk_mul_f32 v[18:19], v[110:111], v[110:111]
    v_pk_mul_f32 v[20:21], v[112:113], v[112:113]
    v_pk_mul_f32 v[22:23], v[114:115], v[114:115]
    v_pk_mul_f32 v[24:25], v[116:117], v[116:117]
    v_pk_mul_f32 v[26:27], v[118:119], v[118:119]
    v_pk_fma_f32 v[16:17], v[16:17], v[76:77], v[74:75] op_sel_hi:[1,0,0]
    v_pk_fma_f32 v[18:19], v[18:19], v[76:77], v[74:75] op_sel_hi:[1,0,0]
    v_pk_fma_f32 v[20:21], v[20:21], v[76:77], v[74:75] op_sel_hi:[1,0,0]
    v_pk_fma_f32 v[22:23], v[22:23], v[76:77], v[74:75] op_sel_hi:[1,0,0]
    v_pk_fma_f32 v[24:25], v[24:25], v[76:77], v[74:75] op_sel_hi:[1,0,0]
    v_pk_fma_f32 v[26:27], v[26:27], v[76:77], v[74:75] op_sel_hi:[1,0,0]
    v_pk_mul_f32 v[16:17], v[16:17], v[108:109]
    v_pk_mul_f32 v[18:19], v[18:19], v[110:111]
    v_pk_mul_f32 v[20:21], v[20:21], v[112:113]
    v_pk_mul_f32 v[22:23], v[22:23], v[114:115]
    v_pk_mul_f32 v[24:25], v[24:25], v[116:117]
    v_pk_mul_f32 v[26:27], v[26:27], v[118:119]
    s_add_u32 s29, s29, 4096
    buffer_load_dwordx4 v[160:163], v5, s[16:19], s29 offen offset:0
    ds_read_b128 v[120:123], v5 offset:18432
    s_waitcnt lgkmcnt(3)
    v_mfma_f32_16x16x32_bf16 v[96:99], a[4:7], v[124:127], v[96:99]
    v_exp_f32 v16, v16
    v_mfma_f32_16x16x32_bf16 v[100:103], a[68:71], v[124:127], v[100:103]
    v_exp_f32 v17, v17
    v_mfma_f32_16x16x32_bf16 v[104:107], a[132:135], v[124:127], v[104:107]
    v_exp_f32 v18, v18
    buffer_load_dwordx4 v[164:167], v5, s[16:19], s29 offen offset:1024
    ds_read_b128 v[124:127], v5 offset:22528
    s_waitcnt lgkmcnt(3)
    v_mfma_f32_16x16x32_bf16 v[96:99], a[8:11], v[128:131], v[96:99]
    v_exp_f32 v19, v19
    v_mfma_f32_16x16x32_bf16 v[100:103], a[72:75], v[128:131], v[100:103]
    v_exp_f32 v20, v20
    v_mfma_f32_16x16x32_bf16 v[104:107], a[136:139], v[128:131], v[104:107]
    v_exp_f32 v21, v21
    buffer_load_dwordx4 v[168:171], v5, s[16:19], s29 offen offset:2048
    ds_read_b128 v[128:131], v5 offset:26624
    s_waitcnt lgkmcnt(3)
    v_mfma_f32_16x16x32_bf16 v[96:99], a[12:15], v[132:135], v[96:99]
    v_exp_f32 v22, v22
    v_mfma_f32_16x16x32_bf16 v[100:103], a[76:79], v[132:135], v[100:103]
    v_exp_f32 v23, v23
    v_mfma_f32_16x16x32_bf16 v[104:107], a[140:143], v[132:135], v[104:107]
    v_exp_f32 v24, v24
    buffer_load_dwordx4 v[172:175], v5, s[16:19], s29 offen offset:3072
    ds_read_b128 v[132:135], v5 offset:30720
    s_waitcnt lgkmcnt(3)
    v_mfma_f32_16x16x32_bf16 v[96:99], a[16:19], v[120:123], v[96:99]
    v_exp_f32 v25, v25
    v_mfma_f32_16x16x32_bf16 v[100:103], a[80:83], v[120:123], v[100:103]
    v_exp_f32 v26, v26
    v_mfma_f32_16x16x32_bf16 v[104:107], a[144:147], v[120:123], v[104:107]
    v_exp_f32 v27, v27
    s_add_u32 s29, s29, 4096
    buffer_load_dwordx4 v[176:179], v5, s[16:19], s29 offen offset:0
    ds_read_b128 v[120:123], v5 offset:34816
    s_waitcnt lgkmcnt(3)
    v_mfma_f32_16x16x32_bf16 v[96:99], a[20:23], v[124:127], v[96:99]
    v_fma_f32 v16, v16, v78, v78
    v_fma_f32 v17, v17, v78, v78
    v_mfma_f32_16x16x32_bf16 v[100:103], a[84:87], v[124:127], v[100:103]
    v_fma_f32 v18, v18, v78, v78
    v_fma_f32 v19, v19, v78, v78
    v_mfma_f32_16x16x32_bf16 v[104:107], a[148:151], v[124:127], v[104:107]
    v_fma_f32 v20, v20, v78, v78
    v_fma_f32 v21, v21, v78, v78
    buffer_load_dwordx4 v[180:183], v5, s[16:19], s29 offen offset:1024
    ds_read_b128 v[124:127], v5 offset:38912
    s_waitcnt lgkmcnt(3)
    v_mfma_f32_16x16x32_bf16 v[96:99], a[24:27], v[128:131], v[96:99]
    v_fma_f32 v22, v22, v78, v78
    v_fma_f32 v23, v23, v78, v78
    v_mfma_f32_16x16x32_bf16 v[100:103], a[88:91], v[128:131], v[100:103]
    v_fma_f32 v24, v24, v78, v78
    v_fma_f32 v25, v25, v78, v78
    v_mfma_f32_16x16x32_bf16 v[104:107], a[152:155], v[128:131], v[104:107]
    v_fma_f32 v26, v26, v78, v78
    v_fma_f32 v27, v27, v78, v78
    buffer_load_dwordx4 v[184:187], v5, s[16:19], s29 offen offset:2048
    ds_read_b128 v[128:131], v5 offset:43008
    s_waitcnt lgkmcnt(3)
    v_mfma_f32_16x16x32_bf16 v[96:99], a[28:31], v[132:135], v[96:99]
    v_rcp_f32 v16, v16
    v_mfma_f32_16x16x32_bf16 v[100:103], a[92:95], v[132:135], v[100:103]
    v_rcp_f32 v17, v17
    v_mfma_f32_16x16x32_bf16 v[104:107], a[156:159], v[132:135], v[104:107]
    v_rcp_f32 v18, v18
    buffer_load_dwordx4 v[188:191], v5, s[16:19], s29 offen offset:3072
    ds_read_b128 v[132:135], v5 offset:47104
    s_waitcnt lgkmcnt(3)
    v_mfma_f32_16x16x32_bf16 v[96:99], a[32:35], v[120:123], v[96:99]
    v_rcp_f32 v19, v19
    v_mfma_f32_16x16x32_bf16 v[100:103], a[96:99], v[120:123], v[100:103]
    v_rcp_f32 v20, v20
    v_mfma_f32_16x16x32_bf16 v[104:107], a[160:163], v[120:123], v[104:107]
    v_rcp_f32 v21, v21
    s_add_u32 s29, s29, 4096
    buffer_load_dwordx4 v[192:195], v5, s[16:19], s29 offen offset:0
    ds_read_b128 v[120:123], v5 offset:51200
    s_waitcnt lgkmcnt(3)
    v_mfma_f32_16x16x32_bf16 v[96:99], a[36:39], v[124:127], v[96:99]
    v_rcp_f32 v22, v22
    v_mfma_f32_16x16x32_bf16 v[100:103], a[100:103], v[124:127], v[100:103]
    v_rcp_f32 v23, v23
    v_mfma_f32_16x16x32_bf16 v[104:107], a[164:167], v[124:127], v[104:107]
    v_rcp_f32 v24, v24
    buffer_load_dwordx4 v[196:199], v5, s[16:19], s29 offen offset:1024
    ds_read_b128 v[124:127], v5 offset:55296
    s_waitcnt lgkmcnt(3)
    v_mfma_f32_16x16x32_bf16 v[96:99], a[40:43], v[128:131], v[96:99]
    v_rcp_f32 v25, v25
    v_mfma_f32_16x16x32_bf16 v[100:103], a[104:107], v[128:131], v[100:103]
    v_rcp_f32 v26, v26
    v_mfma_f32_16x16x32_bf16 v[104:107], a[168:171], v[128:131], v[104:107]
    v_rcp_f32 v27, v27
    buffer_load_dwordx4 v[200:203], v5, s[16:19], s29 offen offset:2048
    ds_read_b128 v[128:131], v5 offset:59392
    s_waitcnt lgkmcnt(3)
    v_mfma_f32_16x16x32_bf16 v[96:99], a[44:47], v[132:135], v[96:99]
    v_mul_f32 v108, v108, v16
    v_mul_f32 v109, v109, v17
    v_mfma_f32_16x16x32_bf16 v[100:103], a[108:111], v[132:135], v[100:103]
    v_mul_f32 v110, v110, v18
    v_mul_f32 v111, v111, v19
    v_mfma_f32_16x16x32_bf16 v[104:107], a[172:175], v[132:135], v[104:107]
    v_mul_f32 v112, v112, v20
    v_mul_f32 v113, v113, v21
    buffer_load_dwordx4 v[204:207], v5, s[16:19], s29 offen offset:3072
    s_waitcnt vmcnt(35)
    s_barrier
    ds_read_b128 v[132:135], v5 offset:63488
    s_waitcnt lgkmcnt(3)
    v_mfma_f32_16x16x32_bf16 v[96:99], a[48:51], v[120:123], v[96:99]
    v_mul_f32 v114, v114, v22
    v_mul_f32 v115, v115, v23
    v_mfma_f32_16x16x32_bf16 v[100:103], a[112:115], v[120:123], v[100:103]
    v_mul_f32 v116, v116, v24
    v_mul_f32 v117, v117, v25
    v_mfma_f32_16x16x32_bf16 v[104:107], a[176:179], v[120:123], v[104:107]
    v_mul_f32 v118, v118, v26
    v_mul_f32 v119, v119, v27
    s_add_u32 s29, s29, 4096
    buffer_load_dwordx4 v[208:211], v5, s[16:19], s29 offen offset:0
    ds_read_b128 v[120:123], v5 offset:3072
    s_waitcnt lgkmcnt(3)
    v_mfma_f32_16x16x32_bf16 v[96:99], a[52:55], v[124:127], v[96:99]
    v_cvt_pk_bf16_f32 v36, v108, v109
    v_cvt_pk_bf16_f32 v37, v110, v111
    v_mfma_f32_16x16x32_bf16 v[100:103], a[116:119], v[124:127], v[100:103]
    v_cvt_pk_bf16_f32 v38, v112, v113
    v_cvt_pk_bf16_f32 v39, v114, v115
    v_mfma_f32_16x16x32_bf16 v[104:107], a[180:183], v[124:127], v[104:107]
    v_cvt_pk_bf16_f32 v40, v116, v117
    v_cvt_pk_bf16_f32 v41, v118, v119
    buffer_load_dwordx4 v[212:215], v5, s[16:19], s29 offen offset:1024
    ds_read_b128 v[124:127], v5 offset:7168
    s_waitcnt lgkmcnt(3)
    v_mfma_f32_16x16x32_bf16 v[96:99], a[56:59], v[128:131], v[96:99]
    buffer_store_dwordx2 v[36:37], v9, s[68:71], s61 offen offset:1024 sc1
    buffer_store_dwordx2 v[38:39], v9, s[68:71], s62 offen offset:1024 sc1
    v_mfma_f32_16x16x32_bf16 v[100:103], a[120:123], v[128:131], v[100:103]
    buffer_store_dwordx2 v[40:41], v9, s[68:71], s63 offen offset:1024 sc1
    v_mfma_f32_16x16x32_bf16 v[104:107], a[184:187], v[128:131], v[104:107]
    buffer_load_dwordx4 v[216:219], v5, s[16:19], s29 offen offset:2048
    ds_read_b128 v[128:131], v5 offset:11264
    s_waitcnt lgkmcnt(3)
    v_mfma_f32_16x16x32_bf16 v[96:99], a[60:63], v[132:135], v[96:99]
    v_mfma_f32_16x16x32_bf16 v[100:103], a[124:127], v[132:135], v[100:103]
    v_mfma_f32_16x16x32_bf16 v[104:107], a[188:191], v[132:135], v[104:107]
    buffer_load_dwordx4 v[220:223], v5, s[16:19], s29 offen offset:3072
    ds_read_b128 v[132:135], v5 offset:15360
    s_waitcnt lgkmcnt(3)
    v_mfma_f32_16x16x32_bf16 v[108:111], a[0:3], v[120:123], 0
    v_mfma_f32_16x16x32_bf16 v[112:115], a[64:67], v[120:123], 0
    v_mfma_f32_16x16x32_bf16 v[116:119], a[128:131], v[120:123], 0
    v_pk_fma_f32 v[96:97], v[48:49], v[80:81], v[96:97] op_sel_hi:[1,0,1]
    v_pk_fma_f32 v[98:99], v[50:51], v[80:81], v[98:99] op_sel_hi:[1,0,1]
    v_pk_fma_f32 v[100:101], v[52:53], v[80:81], v[100:101] op_sel_hi:[1,0,1]
    v_pk_fma_f32 v[102:103], v[54:55], v[80:81], v[102:103] op_sel_hi:[1,0,1]
    v_pk_fma_f32 v[104:105], v[56:57], v[80:81], v[104:105] op_sel_hi:[1,0,1]
    v_pk_fma_f32 v[106:107], v[58:59], v[80:81], v[106:107] op_sel_hi:[1,0,1]
    v_pk_mul_f32 v[16:17], v[96:97], v[96:97]
    v_pk_mul_f32 v[18:19], v[98:99], v[98:99]
    v_pk_mul_f32 v[20:21], v[100:101], v[100:101]
    v_pk_mul_f32 v[22:23], v[102:103], v[102:103]
    v_pk_mul_f32 v[24:25], v[104:105], v[104:105]
    v_pk_mul_f32 v[26:27], v[106:107], v[106:107]
    v_pk_fma_f32 v[16:17], v[16:17], v[84:85], v[82:83] op_sel_hi:[1,0,0]
    v_pk_fma_f32 v[18:19], v[18:19], v[84:85], v[82:83] op_sel_hi:[1,0,0]
    v_pk_fma_f32 v[20:21], v[20:21], v[84:85], v[82:83] op_sel_hi:[1,0,0]
    v_pk_fma_f32 v[22:23], v[22:23], v[84:85], v[82:83] op_sel_hi:[1,0,0]
    v_pk_fma_f32 v[24:25], v[24:25], v[84:85], v[82:83] op_sel_hi:[1,0,0]
    v_pk_fma_f32 v[26:27], v[26:27], v[84:85], v[82:83] op_sel_hi:[1,0,0]
    v_pk_mul_f32 v[16:17], v[16:17], v[96:97]
    v_pk_mul_f32 v[18:19], v[18:19], v[98:99]
    v_pk_mul_f32 v[20:21], v[20:21], v[100:101]
    v_pk_mul_f32 v[22:23], v[22:23], v[102:103]
    v_pk_mul_f32 v[24:25], v[24:25], v[104:105]
    v_pk_mul_f32 v[26:27], v[26:27], v[106:107]
    s_add_u32 s29, s29, 4096
    buffer_load_dwordx4 v[224:227], v5, s[16:19], s29 offen offset:0
    ds_read_b128 v[120:123], v5 offset:19456
    s_waitcnt lgkmcnt(3)
    v_mfma_f32_16x16x32_bf16 v[108:111], a[4:7], v[124:127], v[108:111]
    v_exp_f32 v16, v16
    v_mfma_f32_16x16x32_bf16 v[112:115], a[68:71], v[124:127], v[112:115]
    v_exp_f32 v17, v17
    v_mfma_f32_16x16x32_bf16 v[116:119], a[132:135], v[124:127], v[116:119]
    v_exp_f32 v18, v18
    buffer_load_dwordx4 v[228:231], v5, s[16:19], s29 offen offset:1024
    ds_read_b128 v[124:127], v5 offset:23552
    s_waitcnt lgkmcnt(3)
    v_mfma_f32_16x16x32_bf16 v[108:111], a[8:11], v[128:131], v[108:111]
    v_exp_f32 v19, v19
    v_mfma_f32_16x16x32_bf16 v[112:115], a[72:75], v[128:131], v[112:115]
    v_exp_f32 v20, v20
    v_mfma_f32_16x16x32_bf16 v[116:119], a[136:139], v[128:131], v[116:119]
    v_exp_f32 v21, v21
    buffer_load_dwordx4 v[232:235], v5, s[16:19], s29 offen offset:2048
    ds_read_b128 v[128:131], v5 offset:27648
    s_waitcnt lgkmcnt(3)
    v_mfma_f32_16x16x32_bf16 v[108:111], a[12:15], v[132:135], v[108:111]
    v_exp_f32 v22, v22
    v_mfma_f32_16x16x32_bf16 v[112:115], a[76:79], v[132:135], v[112:115]
    v_exp_f32 v23, v23
    v_mfma_f32_16x16x32_bf16 v[116:119], a[140:143], v[132:135], v[116:119]
    v_exp_f32 v24, v24
    buffer_load_dwordx4 v[236:239], v5, s[16:19], s29 offen offset:3072
    ds_read_b128 v[132:135], v5 offset:31744
    s_waitcnt lgkmcnt(3)
    v_mfma_f32_16x16x32_bf16 v[108:111], a[16:19], v[120:123], v[108:111]
    v_exp_f32 v25, v25
    v_mfma_f32_16x16x32_bf16 v[112:115], a[80:83], v[120:123], v[112:115]
    v_exp_f32 v26, v26
    v_mfma_f32_16x16x32_bf16 v[116:119], a[144:147], v[120:123], v[116:119]
    v_exp_f32 v27, v27
    s_add_u32 s29, s29, 4096
    buffer_load_dwordx4 v[240:243], v5, s[16:19], s29 offen offset:0
    ds_read_b128 v[120:123], v5 offset:35840
    s_waitcnt lgkmcnt(3)
    v_mfma_f32_16x16x32_bf16 v[108:111], a[20:23], v[124:127], v[108:111]
    v_fma_f32 v16, v16, v86, v86
    v_fma_f32 v17, v17, v86, v86
    v_mfma_f32_16x16x32_bf16 v[112:115], a[84:87], v[124:127], v[112:115]
    v_fma_f32 v18, v18, v86, v86
    v_fma_f32 v19, v19, v86, v86
    v_mfma_f32_16x16x32_bf16 v[116:119], a[148:151], v[124:127], v[116:119]
    v_fma_f32 v20, v20, v86, v86
    v_fma_f32 v21, v21, v86, v86
    buffer_load_dwordx4 v[244:247], v5, s[16:19], s29 offen offset:1024
    ds_read_b128 v[124:127], v5 offset:39936
    s_waitcnt lgkmcnt(3)
    v_mfma_f32_16x16x32_bf16 v[108:111], a[24:27], v[128:131], v[108:111]
    v_fma_f32 v22, v22, v86, v86
    v_fma_f32 v23, v23, v86, v86
    v_mfma_f32_16x16x32_bf16 v[112:115], a[88:91], v[128:131], v[112:115]
    v_fma_f32 v24, v24, v86, v86
    v_fma_f32 v25, v25, v86, v86
    v_mfma_f32_16x16x32_bf16 v[116:119], a[152:155], v[128:131], v[116:119]
    v_fma_f32 v26, v26, v86, v86
    v_fma_f32 v27, v27, v86, v86
    buffer_load_dwordx4 v[248:251], v5, s[16:19], s29 offen offset:2048
    ds_read_b128 v[128:131], v5 offset:44032
    s_waitcnt lgkmcnt(3)
    v_mfma_f32_16x16x32_bf16 v[108:111], a[28:31], v[132:135], v[108:111]
    v_rcp_f32 v16, v16
    v_mfma_f32_16x16x32_bf16 v[112:115], a[92:95], v[132:135], v[112:115]
    v_rcp_f32 v17, v17
    v_mfma_f32_16x16x32_bf16 v[116:119], a[156:159], v[132:135], v[116:119]
    v_rcp_f32 v18, v18
    buffer_load_dwordx4 v[252:255], v5, s[16:19], s29 offen offset:3072
    ds_read_b128 v[132:135], v5 offset:48128
    s_waitcnt lgkmcnt(3)
    v_mfma_f32_16x16x32_bf16 v[108:111], a[32:35], v[120:123], v[108:111]
    v_rcp_f32 v19, v19
    v_mfma_f32_16x16x32_bf16 v[112:115], a[96:99], v[120:123], v[112:115]
    v_rcp_f32 v20, v20
    v_mfma_f32_16x16x32_bf16 v[116:119], a[160:163], v[120:123], v[116:119]
    v_rcp_f32 v21, v21
    ds_read_b128 v[120:123], v5 offset:52224
    s_waitcnt lgkmcnt(3)
    v_mfma_f32_16x16x32_bf16 v[108:111], a[36:39], v[124:127], v[108:111]
    v_rcp_f32 v22, v22
    v_mfma_f32_16x16x32_bf16 v[112:115], a[100:103], v[124:127], v[112:115]
    v_rcp_f32 v23, v23
    v_mfma_f32_16x16x32_bf16 v[116:119], a[164:167], v[124:127], v[116:119]
    v_rcp_f32 v24, v24
    ds_read_b128 v[124:127], v5 offset:56320
    s_waitcnt lgkmcnt(3)
    v_mfma_f32_16x16x32_bf16 v[108:111], a[40:43], v[128:131], v[108:111]
    v_rcp_f32 v25, v25
    v_mfma_f32_16x16x32_bf16 v[112:115], a[104:107], v[128:131], v[112:115]
    v_rcp_f32 v26, v26
    v_mfma_f32_16x16x32_bf16 v[116:119], a[168:171], v[128:131], v[116:119]
    v_rcp_f32 v27, v27
    ds_read_b128 v[128:131], v5 offset:60416
    s_waitcnt lgkmcnt(3)
    v_mfma_f32_16x16x32_bf16 v[108:111], a[44:47], v[132:135], v[108:111]
    v_mul_f32 v96, v96, v16
    v_mul_f32 v97, v97, v17
    v_mfma_f32_16x16x32_bf16 v[112:115], a[108:111], v[132:135], v[112:115]
    v_mul_f32 v98, v98, v18
    v_mul_f32 v99, v99, v19
    v_mfma_f32_16x16x32_bf16 v[116:119], a[172:175], v[132:135], v[116:119]
    v_mul_f32 v100, v100, v20
    v_mul_f32 v101, v101, v21
    ds_read_b128 v[132:135], v5 offset:64512
    s_waitcnt lgkmcnt(3)
    v_mfma_f32_16x16x32_bf16 v[108:111], a[48:51], v[120:123], v[108:111]
    v_mul_f32 v102, v102, v22
    v_mul_f32 v103, v103, v23
    v_mfma_f32_16x16x32_bf16 v[112:115], a[112:115], v[120:123], v[112:115]
    v_mul_f32 v104, v104, v24
    v_mul_f32 v105, v105, v25
    v_mfma_f32_16x16x32_bf16 v[116:119], a[176:179], v[120:123], v[116:119]
    v_mul_f32 v106, v106, v26
    v_mul_f32 v107, v107, v27
    s_waitcnt lgkmcnt(2)
    v_mfma_f32_16x16x32_bf16 v[108:111], a[52:55], v[124:127], v[108:111]
    v_cvt_pk_bf16_f32 v28, v96, v97
    v_cvt_pk_bf16_f32 v29, v98, v99
    v_mfma_f32_16x16x32_bf16 v[112:115], a[116:119], v[124:127], v[112:115]
    v_cvt_pk_bf16_f32 v30, v100, v101
    v_cvt_pk_bf16_f32 v31, v102, v103
    v_mfma_f32_16x16x32_bf16 v[116:119], a[180:183], v[124:127], v[116:119]
    v_cvt_pk_bf16_f32 v32, v104, v105
    v_cvt_pk_bf16_f32 v33, v106, v107
    s_waitcnt lgkmcnt(1)
    v_mfma_f32_16x16x32_bf16 v[108:111], a[56:59], v[128:131], v[108:111]
    buffer_store_dwordx2 v[28:29], v9, s[68:71], s61 offen offset:2048 sc1
    buffer_store_dwordx2 v[30:31], v9, s[68:71], s62 offen offset:2048 sc1
    v_mfma_f32_16x16x32_bf16 v[112:115], a[120:123], v[128:131], v[112:115]
    buffer_store_dwordx2 v[32:33], v9, s[68:71], s63 offen offset:2048 sc1
    v_mfma_f32_16x16x32_bf16 v[116:119], a[184:187], v[128:131], v[116:119]
    s_waitcnt lgkmcnt(0)
    v_mfma_f32_16x16x32_bf16 v[108:111], a[60:63], v[132:135], v[108:111]
    v_mfma_f32_16x16x32_bf16 v[112:115], a[124:127], v[132:135], v[112:115]
    v_mfma_f32_16x16x32_bf16 v[116:119], a[188:191], v[132:135], v[116:119]
    s_nop 5
    v_pk_fma_f32 v[108:109], v[48:49], v[88:89], v[108:109] op_sel_hi:[1,0,1]
    v_pk_fma_f32 v[110:111], v[50:51], v[88:89], v[110:111] op_sel_hi:[1,0,1]
    v_pk_fma_f32 v[112:113], v[52:53], v[88:89], v[112:113] op_sel_hi:[1,0,1]
    v_pk_fma_f32 v[114:115], v[54:55], v[88:89], v[114:115] op_sel_hi:[1,0,1]
    v_pk_fma_f32 v[116:117], v[56:57], v[88:89], v[116:117] op_sel_hi:[1,0,1]
    v_pk_fma_f32 v[118:119], v[58:59], v[88:89], v[118:119] op_sel_hi:[1,0,1]
    v_pk_mul_f32 v[16:17], v[108:109], v[108:109]
    v_pk_mul_f32 v[18:19], v[110:111], v[110:111]
    v_pk_mul_f32 v[20:21], v[112:113], v[112:113]
    v_pk_mul_f32 v[22:23], v[114:115], v[114:115]
    v_pk_mul_f32 v[24:25], v[116:117], v[116:117]
    v_pk_mul_f32 v[26:27], v[118:119], v[118:119]
    v_pk_fma_f32 v[16:17], v[16:17], v[92:93], v[90:91] op_sel_hi:[1,0,0]
    v_pk_fma_f32 v[18:19], v[18:19], v[92:93], v[90:91] op_sel_hi:[1,0,0]
    v_pk_fma_f32 v[20:21], v[20:21], v[92:93], v[90:91] op_sel_hi:[1,0,0]
    v_pk_fma_f32 v[22:23], v[22:23], v[92:93], v[90:91] op_sel_hi:[1,0,0]
    v_pk_fma_f32 v[24:25], v[24:25], v[92:93], v[90:91] op_sel_hi:[1,0,0]
    v_pk_fma_f32 v[26:27], v[26:27], v[92:93], v[90:91] op_sel_hi:[1,0,0]
    v_pk_mul_f32 v[16:17], v[16:17], v[108:109]
    v_pk_mul_f32 v[18:19], v[18:19], v[110:111]
    v_pk_mul_f32 v[20:21], v[20:21], v[112:113]
    v_pk_mul_f32 v[22:23], v[22:23], v[114:115]
    v_pk_mul_f32 v[24:25], v[24:25], v[116:117]
    v_pk_mul_f32 v[26:27], v[26:27], v[118:119]
    v_exp_f32 v16, v16
    v_exp_f32 v17, v17
    v_exp_f32 v18, v18
    v_exp_f32 v19, v19
    v_exp_f32 v20, v20
    v_exp_f32 v21, v21
    v_exp_f32 v22, v22
    v_exp_f32 v23, v23
    v_exp_f32 v24, v24
    v_exp_f32 v25, v25
    v_exp_f32 v26, v26
    v_exp_f32 v27, v27
    v_fma_f32 v16, v16, v94, v94
    v_fma_f32 v17, v17, v94, v94
    v_fma_f32 v18, v18, v94, v94
    v_fma_f32 v19, v19, v94, v94
    v_fma_f32 v20, v20, v94, v94
    v_fma_f32 v21, v21, v94, v94
    v_fma_f32 v22, v22, v94, v94
    v_fma_f32 v23, v23, v94, v94
    v_fma_f32 v24, v24, v94, v94
    v_fma_f32 v25, v25, v94, v94
    v_fma_f32 v26, v26, v94, v94
    v_fma_f32 v27, v27, v94, v94
    v_rcp_f32 v16, v16
    v_rcp_f32 v17, v17
    v_rcp_f32 v18, v18
    v_rcp_f32 v19, v19
    v_rcp_f32 v20, v20
    v_rcp_f32 v21, v21
    v_rcp_f32 v22, v22
    v_rcp_f32 v23, v23
    v_rcp_f32 v24, v24
    v_rcp_f32 v25, v25
    v_rcp_f32 v26, v26
    v_rcp_f32 v27, v27
    v_mul_f32 v108, v108, v16
    v_mul_f32 v109, v109, v17
    v_mul_f32 v110, v110, v18
    v_mul_f32 v111, v111, v19
    v_mul_f32 v112, v112, v20
    v_mul_f32 v113, v113, v21
    v_mul_f32 v114, v114, v22
    v_mul_f32 v115, v115, v23
    v_mul_f32 v116, v116, v24
    v_mul_f32 v117, v117, v25
    v_mul_f32 v118, v118, v26
    v_mul_f32 v119, v119, v27
    v_cvt_pk_bf16_f32 v36, v108, v109
    v_cvt_pk_bf16_f32 v37, v110, v111
    v_cvt_pk_bf16_f32 v38, v112, v113
    v_cvt_pk_bf16_f32 v39, v114, v115
    v_cvt_pk_bf16_f32 v40, v116, v117
    v_cvt_pk_bf16_f32 v41, v118, v119
    buffer_store_dwordx2 v[36:37], v9, s[68:71], s61 offen offset:3072 sc1
    buffer_store_dwordx2 v[38:39], v9, s[68:71], s62 offen offset:3072 sc1
    buffer_store_dwordx2 v[40:41], v9, s[68:71], s63 offen offset:3072 sc1
    s_waitcnt vmcnt(0)
    s_barrier
    s_cmp_eq_u32 s42, 0
    s_cbranch_scc0 .Lmlp_ke_pub_15
    s_lshr_b32 s44, s25, 2
    s_lshl_b32 s44, s44, 6
    s_and_b32 s45, s25, 3
    s_lshl_b32 s45, s45, 2
    s_add_u32 s44, s44, s45
    s_add_u32 s44, s44, 32768
    v_mov_b32 v6, s24
    v_mov_b32 v7, 0x7ff00000
    v_cmp_eq_u32 vcc, 0, v2
    s_nop 1
    v_cndmask_b32 v7, v7, v2, vcc
    buffer_store_dword v6, v7, s[20:23], s44 offen sc1
.Lmlp_ke_pub_15:
    s_mul_i32 s44, s90, 176128
    s_mul_i32 s45, s42, 45056
    s_add_u32 s44, s44, s45
    s_add_u32 s56, s40, 0x1100000
    s_addc_u32 s57, s41, 0
    s_add_u32 s56, s56, s44
    s_addc_u32 s57, s57, 0
    s_sub_u32 s58, 176128, s45
    s_mov_b32 s59, 0x20000
    s_add_u32 s52, s40, 0xd00000
    s_addc_u32 s53, s41, 0
    s_mov_b32 s54, 0x200000
    s_mov_b32 s55, 0x20000
    s_add_u32 s64, s40, 0x1c00000
    s_addc_u32 s65, s41, 0
    s_mov_b32 s66, 0x3000
    s_mov_b32 s67, 0x20000
    s_mov_b32 s76, s36
    s_mov_b32 s77, s37
    s_mov_b32 s78, 0x200000
    s_mov_b32 s79, 0x20000
    s_and_b32 s44, s42, 1
    s_lshl_b32 s44, s44, 3
    v_add_u32 v20, s44, v5
    s_lshl_b32 s75, s90, 16
    s_lshl_b32 s44, s91, 13
    s_add_u32 s75, s75, s44
    s_lshr_b32 s44, s42, 1
    s_lshl_b32 s44, s44, 12
    s_add_u32 s75, s75, s44
    buffer_load_dwordx2 v[96:97], v20, s[48:51], s75 offen offset:0 sc1
    buffer_load_dwordx2 v[104:105], v20, s[52:55], s75 offen offset:0 sc1
    buffer_load_dwordx2 v[98:99], v20, s[48:51], s75 offen offset:1024 sc1
    buffer_load_dwordx2 v[106:107], v20, s[52:55], s75 offen offset:1024 sc1
    buffer_load_dwordx2 v[100:101], v20, s[48:51], s75 offen offset:2048 sc1
    buffer_load_dwordx2 v[108:109], v20, s[52:55], s75 offen offset:2048 sc1
    buffer_load_dwordx2 v[102:103], v20, s[48:51], s75 offen offset:3072 sc1
    buffer_load_dwordx2 v[110:111], v20, s[52:55], s75 offen offset:3072 sc1
    s_lshl_b32 s45, s91, 8
    s_add_u32 s45, s45, 10240
    s_lshr_b32 s44, s42, 1
    s_lshl_b32 s44, s44, 7
    s_add_u32 s45, s45, s44
    s_and_b32 s44, s42, 1
    s_lshl_b32 s44, s44, 4
    s_add_u32 s45, s45, s44
    v_lshlrev_b32 v6, 5, v4
    buffer_load_dwordx4 v[12:15], v6, s[64:67], s45 offen sc1
    s_lshl_b32 s44, s42, 12
    v_add_u32 v21, s44, v5
    s_lshl_b32 s44, s42, 10
    v_add_u32 v22, s44, v5
    v_add_u32 v23, s95, v3
    v_lshlrev_b32 v23, 10, v23
    v_lshl_add_u32 v23, v4, 4, v23
    s_lshl_b32 s74, s91, 7
    s_lshr_b32 s44, s42, 1
    s_lshl_b32 s44, s44, 6
    s_add_u32 s74, s74, s44
    s_and_b32 s44, s42, 1
    s_lshl_b32 s44, s44, 3
    s_add_u32 s74, s74, s44
    s_lshl_b32 s43, s90, 3
    s_cmp_eq_u32 s42, 0
    s_cbranch_scc0 .Lmlp_ke_aw_16
    s_ashr_i32 s44, s43, 2
    s_add_i32 s45, s44, 0
    s_max_i32 s45, s45, 0
    s_min_i32 s45, s45, 63
    s_lshl_b32 s45, s45, 6
    s_add_u32 s45, s45, 0x1d08000
    s_add_u32 s80, s40, s45
    s_addc_u32 s81, s41, 0
    s_add_i32 s45, s44, 1
    s_max_i32 s45, s45, 0
    s_min_i32 s45, s45, 63
    s_lshl_b32 s45, s45, 6
    s_add_u32 s45, s45, 0x1d08000
    s_add_u32 s82, s40, s45
    s_addc_u32 s83, s41, 0
    s_mov_b32 s44, 0
.Lmlp_ke_poll_17:
    s_load_dwordx4 s[4:7], s[80:81], 0 glc
    s_load_dwordx4 s[96:99], s[82:83], 0 glc
    s_waitcnt lgkmcnt(0)
    s_and_b32 s4, s4, s5
    s_and_b32 s6, s6, s7
    s_and_b32 s4, s4, s6
    s_and_b32 s96, s96, s97
    s_and_b32 s98, s98, s99
    s_and_b32 s96, s96, s98
    s_and_b32 s4, s4, s96
    s_cmp_eq_u32 s4, s24
    s_cbranch_scc1 .Lmlp_ke_pout_18
    s_add_u32 s44, s44, 1
    s_cmp_lt_u32 s44, 0x40000
    s_cbranch_scc1 .Lmlp_ke_poll_17
.Lmlp_ke_pout_18:
.Lmlp_ke_aw_16:
    s_barrier
    s_movk_i32 s73, 0
    buffer_load_dwordx4 a[0:3], v5, s[56:59], s73 offen offset:0 sc1
    s_movk_i32 s73, 4096
    buffer_load_dwordx4 a[4:7], v5, s[56:59], s73 offen offset:0 sc1
    s_movk_i32 s73, 8192
    buffer_load_dwordx4 a[8:11], v5, s[56:59], s73 offen offset:0 sc1
    s_movk_i32 s73, 12288
    buffer_load_dwordx4 a[12:15], v5, s[56:59], s73 offen offset:0 sc1
    s_movk_i32 s73, 16384
    buffer_load_dwordx4 a[16:19], v5, s[56:59], s73 offen offset:0 sc1
    s_movk_i32 s73, 20480
    buffer_load_dwordx4 a[20:23], v5, s[56:59], s73 offen offset:0 sc1
    s_movk_i32 s73, 24576
    buffer_load_dwordx4 a[24:27], v5, s[56:59], s73 offen offset:0 sc1
    s_movk_i32 s73, 28672
    buffer_load_dwordx4 a[28:31], v5, s[56:59], s73 offen offset:0 sc1
    s_mov_b32 s73, 32768
    buffer_load_dwordx4 a[32:35], v5, s[56:59], s73 offen offset:0 sc1
    s_mov_b32 s73, 36864
    buffer_load_dwordx4 a[36:39], v5, s[56:59], s73 offen offset:0 sc1
    s_waitcnt vmcnt(9)
    v_mfma_f32_16x16x32_bf16 a[128:131], a[192:195], a[0:3], 0
    v_mfma_f32_16x16x32_bf16 a[132:135], a[196:199], a[0:3], 0
    v_mfma_f32_16x16x32_bf16 a[136:139], a[200:203], a[0:3], 0
    v_mfma_f32_16x16x32_bf16 a[140:143], a[204:207], a[0:3], 0
    s_mov_b32 s73, 40960
    buffer_load_dwordx4 a[40:43], v5, s[56:59], s73 offen offset:0 sc1
    s_waitcnt vmcnt(9)
    v_mfma_f32_16x16x32_bf16 a[128:131], a[208:211], a[4:7], a[128:131]
    v_mfma_f32_16x16x32_bf16 a[132:135], a[212:215], a[4:7], a[132:135]
    v_mfma_f32_16x16x32_bf16 a[136:139], a[216:219], a[4:7], a[136:139]
    v_mfma_f32_16x16x32_bf16 a[140:143], a[220:223], a[4:7], a[140:143]
    s_movk_i32 s73, 0
    buffer_load_dwordx4 a[44:47], v5, s[56:59], s73 offen offset:1024 sc1
    s_waitcnt vmcnt(9)
    v_mfma_f32_16x16x32_bf16 a[128:131], a[224:227], a[8:11], a[128:131]
    v_mfma_f32_16x16x32_bf16 a[132:135], a[228:231], a[8:11], a[132:135]
    v_mfma_f32_16x16x32_bf16 a[136:139], a[232:235], a[8:11], a[136:139]
    v_mfma_f32_16x16x32_bf16 a[140:143], a[236:239], a[8:11], a[140:143]
    s_movk_i32 s73, 4096
    buffer_load_dwordx4 a[48:51], v5, s[56:59], s73 offen offset:1024 sc1
    s_waitcnt vmcnt(9)
    v_mfma_f32_16x16x32_bf16 a[128:131], a[240:243], a[12:15], a[128:131]
    v_mfma_f32_16x16x32_bf16 a[132:135], a[244:247], a[12:15], a[132:135]
    v_mfma_f32_16x16x32_bf16 a[136:139], a[248:251], a[12:15], a[136:139]
    v_mfma_f32_16x16x32_bf16 a[140:143], a[252:255], a[12:15], a[140:143]
    s_movk_i32 s73, 8192
    buffer_load_dwordx4 a[52:55], v5, s[56:59], s73 offen offset:1024 sc1
    s_waitcnt vmcnt(9)
    v_mfma_f32_16x16x32_bf16 a[128:131], v[144:147], a[16:19], a[128:131]
    v_mfma_f32_16x16x32_bf16 a[132:135], v[148:151], a[16:19], a[132:135]
    v_mfma_f32_16x16x32_bf16 a[136:139], v[152:155], a[16:19], a[136:139]
    v_mfma_f32_16x16x32_bf16 a[140:143], v[156:159], a[16:19], a[140:143]
    s_movk_i32 s73, 12288
    buffer_load_dwordx4 a[56:59], v5, s[56:59], s73 offen offset:1024 sc1
    s_waitcnt vmcnt(9)
    v_mfma_f32_16x16x32_bf16 a[128:131], v[160:163], a[20:23], a[128:131]
    v_mfma_f32_16x16x32_bf16 a[132:135], v[164:167], a[20:23], a[132:135]
    v_mfma_f32_16x16x32_bf16 a[136:139], v[168:171], a[20:23], a[136:139]
    v_mfma_f32_16x16x32_bf16 a[140:143], v[172:175], a[20:23], a[140:143]
    s_movk_i32 s73, 16384
    buffer_load_dwordx4 a[60:63], v5, s[56:59], s73 offen offset:1024 sc1
    s_waitcnt vmcnt(9)
    v_mfma_f32_16x16x32_bf16 a[128:131], v[176:179], a[24:27], a[128:131]
    v_mfma_f32_16x16x32_bf16 a[132:135], v[180:183], a[24:27], a[132:135]
    v_mfma_f32_16x16x32_bf16 a[136:139], v[184:187], a[24:27], a[136:139]
    v_mfma_f32_16x16x32_bf16 a[140:143], v[188:191], a[24:27], a[140:143]
    s_movk_i32 s73, 20480
    buffer_load_dwordx4 a[64:67], v5, s[56:59], s73 offen offset:1024 sc1
    s_waitcnt vmcnt(9)
    v_mfma_f32_16x16x32_bf16 a[128:131], v[192:195], a[28:31], a[128:131]
    v_mfma_f32_16x16x32_bf16 a[132:135], v[196:199], a[28:31], a[132:135]
    v_mfma_f32_16x16x32_bf16 a[136:139], v[200:203], a[28:31], a[136:139]
    v_mfma_f32_16x16x32_bf16 a[140:143], v[204:207], a[28:31], a[140:143]
    s_movk_i32 s73, 24576
    buffer_load_dwordx4 a[68:71], v5, s[56:59], s73 offen offset:1024 sc1
    s_waitcnt vmcnt(9)
    v_mfma_f32_16x16x32_bf16 a[128:131], v[208:211], a[32:35], a[128:131]
    v_mfma_f32_16x16x32_bf16 a[132:135], v[212:215], a[32:35], a[132:135]
    v_mfma_f32_16x16x32_bf16 a[136:139], v[216:219], a[32:35], a[136:139]
    v_mfma_f32_16x16x32_bf16 a[140:143], v[220:223], a[32:35], a[140:143]
    s_movk_i32 s73, 28672
    buffer_load_dwordx4 a[72:75], v5, s[56:59], s73 offen offset:1024 sc1
    s_waitcnt vmcnt(9)
    v_mfma_f32_16x16x32_bf16 a[128:131], v[224:227], a[36:39], a[128:131]
    v_mfma_f32_16x16x32_bf16 a[132:135], v[228:231], a[36:39], a[132:135]
    v_mfma_f32_16x16x32_bf16 a[136:139], v[232:235], a[36:39], a[136:139]
    v_mfma_f32_16x16x32_bf16 a[140:143], v[236:239], a[36:39], a[140:143]
    s_mov_b32 s73, 32768
    buffer_load_dwordx4 a[76:79], v5, s[56:59], s73 offen offset:1024 sc1
    s_waitcnt vmcnt(9)
    v_mfma_f32_16x16x32_bf16 a[128:131], v[240:243], a[40:43], a[128:131]
    v_mfma_f32_16x16x32_bf16 a[132:135], v[244:247], a[40:43], a[132:135]
    v_mfma_f32_16x16x32_bf16 a[136:139], v[248:251], a[40:43], a[136:139]
    v_mfma_f32_16x16x32_bf16 a[140:143], v[252:255], a[40:43], a[140:143]
    s_mov_b32 s73, 36864
    buffer_load_dwordx4 a[80:83], v5, s[56:59], s73 offen offset:1024 sc1
    s_nop 2
    ds_write_b128 v21, a[128:131] offset:0
    ds_write_b128 v21, a[132:135] offset:1024
    ds_write_b128 v21, a[136:139] offset:2048
    ds_write_b128 v21, a[140:143] offset:3072
    s_waitcnt vmcnt(9)
    v_mfma_f32_16x16x32_bf16 a[144:147], a[192:195], a[44:47], 0
    v_mfma_f32_16x16x32_bf16 a[148:151], a[196:199], a[44:47], 0
    v_mfma_f32_16x16x32_bf16 a[152:155], a[200:203], a[44:47], 0
    v_mfma_f32_16x16x32_bf16 a[156:159], a[204:207], a[44:47], 0
    s_mov_b32 s73, 40960
    buffer_load_dwordx4 a[84:87], v5, s[56:59], s73 offen offset:1024 sc1
    s_waitcnt vmcnt(9)
    v_mfma_f32_16x16x32_bf16 a[144:147], a[208:211], a[48:51], a[144:147]
    v_mfma_f32_16x16x32_bf16 a[148:151], a[212:215], a[48:51], a[148:151]
    v_mfma_f32_16x16x32_bf16 a[152:155], a[216:219], a[48:51], a[152:155]
    v_mfma_f32_16x16x32_bf16 a[156:159], a[220:223], a[48:51], a[156:159]
    s_movk_i32 s73, 0
    buffer_load_dwordx4 a[88:91], v5, s[56:59], s73 offen offset:2048 sc1
    s_waitcnt lgkmcnt(0)
    s_barrier
    ds_read_b128 v[32:35], v22 offset:0
    ds_read_b128 v[36:39], v22 offset:4096
    ds_read_b128 v[40:43], v22 offset:8192
    ds_read_b128 v[44:47], v22 offset:12288
    s_waitcnt vmcnt(9)
    v_mfma_f32_16x16x32_bf16 a[144:147], a[224:227], a[52:55], a[144:147]
    v_mfma_f32_16x16x32_bf16 a[148:151], a[228:231], a[52:55], a[148:151]
    v_mfma_f32_16x16x32_bf16 a[152:155], a[232:235], a[52:55], a[152:155]
    v_mfma_f32_16x16x32_bf16 a[156:159], a[236:239], a[52:55], a[156:159]
    s_movk_i32 s73, 4096
    buffer_load_dwordx4 a[92:95], v5, s[56:59], s73 offen offset:2048 sc1
    s_waitcnt vmcnt(9)
    v_mfma_f32_16x16x32_bf16 a[144:147], a[240:243], a[56:59], a[144:147]
    v_mfma_f32_16x16x32_bf16 a[148:151], a[244:247], a[56:59], a[148:151]
    v_mfma_f32_16x16x32_bf16 a[152:155], a[248:251], a[56:59], a[152:155]
    v_mfma_f32_16x16x32_bf16 a[156:159], a[252:255], a[56:59], a[156:159]
    s_movk_i32 s73, 8192
    buffer_load_dwordx4 a[96:99], v5, s[56:59], s73 offen offset:2048 sc1
    s_waitcnt lgkmcnt(0)
    s_waitcnt vmcnt(9)
    v_mfma_f32_16x16x32_bf16 a[144:147], v[144:147], a[60:63], a[144:147]
    v_add_f32 v32, v32, v36
    v_add_f32 v33, v33, v37
    v_mfma_f32_16x16x32_bf16 a[148:151], v[148:151], a[60:63], a[148:151]
    v_add_f32 v34, v34, v38
    v_add_f32 v35, v35, v39
    v_mfma_f32_16x16x32_bf16 a[152:155], v[152:155], a[60:63], a[152:155]
    v_add_f32 v40, v40, v44
    v_add_f32 v41, v41, v45
    v_mfma_f32_16x16x32_bf16 a[156:159], v[156:159], a[60:63], a[156:159]
    v_add_f32 v42, v42, v46
    v_add_f32 v43, v43, v47
    s_movk_i32 s73, 12288
    buffer_load_dwordx4 a[100:103], v5, s[56:59], s73 offen offset:2048 sc1
    s_waitcnt vmcnt(9)
    v_mfma_f32_16x16x32_bf16 a[144:147], v[160:163], a[64:67], a[144:147]
    v_lshlrev_b32 v48, 16, v96
    v_and_b32 v49, 0xffff0000, v96
    v_mfma_f32_16x16x32_bf16 a[148:151], v[164:167], a[64:67], a[148:151]
    v_lshlrev_b32 v50, 16, v97
    v_and_b32 v51, 0xffff0000, v97
    v_mfma_f32_16x16x32_bf16 a[152:155], v[168:171], a[64:67], a[152:155]
    v_add_f32 v32, v32, v40
    v_add_f32 v33, v33, v41
    v_mfma_f32_16x16x32_bf16 a[156:159], v[172:175], a[64:67], a[156:159]
    v_add_f32 v34, v34, v42
    v_add_f32 v35, v35, v43
    s_movk_i32 s73, 16384
    buffer_load_dwordx4 a[104:107], v5, s[56:59], s73 offen offset:2048 sc1
    s_waitcnt vmcnt(9)
    v_mfma_f32_16x16x32_bf16 a[144:147], v[176:179], a[68:71], a[144:147]
    v_lshlrev_b32 v52, 16, v104
    v_and_b32 v53, 0xffff0000, v104
    v_mfma_f32_16x16x32_bf16 a[148:151], v[180:183], a[68:71], a[148:151]
    v_lshlrev_b32 v54, 16, v105
    v_and_b32 v55, 0xffff0000, v105
    v_mfma_f32_16x16x32_bf16 a[152:155], v[184:187], a[68:71], a[152:155]
    v_add_f32 v32, v32, v48
    v_add_f32 v33, v33, v49
    v_mfma_f32_16x16x32_bf16 a[156:159], v[188:191], a[68:71], a[156:159]
    v_add_f32 v34, v34, v50
    v_add_f32 v35, v35, v51
    s_movk_i32 s73, 20480
    buffer_load_dwordx4 a[108:111], v5, s[56:59], s73 offen offset:2048 sc1
    s_waitcnt vmcnt(9)
    v_mfma_f32_16x16x32_bf16 a[144:147], v[192:195], a[72:75], a[144:147]
    v_fma_f32 v32, v32, v12, v52
    v_fma_f32 v33, v33, v13, v53
    v_mfma_f32_16x16x32_bf16 a[148:151], v[196:199], a[72:75], a[148:151]
    v_fma_f32 v34, v34, v14, v54
    v_fma_f32 v35, v35, v15, v55
    v_mfma_f32_16x16x32_bf16 a[152:155], v[200:203], a[72:75], a[152:155]
    v_cvt_pk_bf16_f32 v56, v32, v33
    v_cvt_pk_bf16_f32 v57, v34, v35
    v_mfma_f32_16x16x32_bf16 a[156:159], v[204:207], a[72:75], a[156:159]
    s_add_u32 s43, s74, 0
    buffer_store_dwordx2 v[56:57], v23, s[76:79], s43 offen
    s_movk_i32 s73, 24576
    buffer_load_dwordx4 a[112:115], v5, s[56:59], s73 offen offset:2048 sc1
    s_waitcnt vmcnt(10)
    v_mfma_f32_16x16x32_bf16 a[144:147], v[208:211], a[76:79], a[144:147]
    v_mfma_f32_16x16x32_bf16 a[148:151], v[212:215], a[76:79], a[148:151]
    v_mfma_f32_16x16x32_bf16 a[152:155], v[216:219], a[76:79], a[152:155]
    v_mfma_f32_16x16x32_bf16 a[156:159], v[220:223], a[76:79], a[156:159]
    s_movk_i32 s73, 28672
    buffer_load_dwordx4 a[116:119], v5, s[56:59], s73 offen offset:2048 sc1
    s_waitcnt vmcnt(10)
    v_mfma_f32_16x16x32_bf16 a[144:147], v[224:227], a[80:83], a[144:147]
    v_mfma_f32_16x16x32_bf16 a[148:151], v[228:231], a[80:83], a[148:151]
    v_mfma_f32_16x16x32_bf16 a[152:155], v[232:235], a[80:83], a[152:155]
    v_mfma_f32_16x16x32_bf16 a[156:159], v[236:239], a[80:83], a[156:159]
    s_mov_b32 s73, 32768
    buffer_load_dwordx4 a[120:123], v5, s[56:59], s73 offen offset:2048 sc1
    s_waitcnt vmcnt(10)
    v_mfma_f32_16x16x32_bf16 a[144:147], v[240:243], a[84:87], a[144:147]
    v_mfma_f32_16x16x32_bf16 a[148:151], v[244:247], a[84:87], a[148:151]
    v_mfma_f32_16x16x32_bf16 a[152:155], v[248:251], a[84:87], a[152:155]
    v_mfma_f32_16x16x32_bf16 a[156:159], v[252:255], a[84:87], a[156:159]
    s_mov_b32 s73, 36864
    buffer_load_dwordx4 a[124:127], v5, s[56:59], s73 offen offset:2048 sc1
    s_nop 2
    ds_write_b128 v21, a[144:147] offset:16384
    ds_write_b128 v21, a[148:151] offset:17408
    ds_write_b128 v21, a[152:155] offset:18432
    ds_write_b128 v21, a[156:159] offset:19456
    s_waitcnt vmcnt(10)
    v_mfma_f32_16x16x32_bf16 a[128:131], a[192:195], a[88:91], 0
    v_mfma_f32_16x16x32_bf16 a[132:135], a[196:199], a[88:91], 0
    v_mfma_f32_16x16x32_bf16 a[136:139], a[200:203], a[88:91], 0
    v_mfma_f32_16x16x32_bf16 a[140:143], a[204:207], a[88:91], 0
    s_mov_b32 s73, 40960
    buffer_load_dwordx4 a[0:3], v5, s[56:59], s73 offen offset:2048 sc1
    s_waitcnt vmcnt(10)
    v_mfma_f32_16x16x32_bf16 a[128:131], a[208:211], a[92:95], a[128:131]
    v_mfma_f32_16x16x32_bf16 a[132:135], a[212:215], a[92:95], a[132:135]
    v_mfma_f32_16x16x32_bf16 a[136:139], a[216:219], a[92:95], a[136:139]
    v_mfma_f32_16x16x32_bf16 a[140:143], a[220:223], a[92:95], a[140:143]
    s_movk_i32 s73, 0
    buffer_load_dwordx4 a[4:7], v5, s[56:59], s73 offen offset:3072 sc1
    s_waitcnt lgkmcnt(0)
    s_barrier
    ds_read_b128 v[32:35], v22 offset:16384
    ds_read_b128 v[36:39], v22 offset:20480
    ds_read_b128 v[40:43], v22 offset:24576
    ds_read_b128 v[44:47], v22 offset:28672
    s_waitcnt vmcnt(10)
    v_mfma_f32_16x16x32_bf16 a[128:131], a[224:227], a[96:99], a[128:131]
    v_mfma_f32_16x16x32_bf16 a[132:135], a[228:231], a[96:99], a[132:135]
    v_mfma_f32_16x16x32_bf16 a[136:139], a[232:235], a[96:99], a[136:139]
    v_mfma_f32_16x16x32_bf16 a[140:143], a[236:239], a[96:99], a[140:143]
    s_movk_i32 s73, 4096
    buffer_load_dwordx4 a[8:11], v5, s[56:59], s73 offen offset:3072 sc1
    s_waitcnt vmcnt(10)
    v_mfma_f32_16x16x32_bf16 a[128:131], a[240:243], a[100:103], a[128:131]
    v_mfma_f32_16x16x32_bf16 a[132:135], a[244:247], a[100:103], a[132:135]
    v_mfma_f32_16x16x32_bf16 a[136:139], a[248:251], a[100:103], a[136:139]
    v_mfma_f32_16x16x32_bf16 a[140:143], a[252:255], a[100:103], a[140:143]
    s_movk_i32 s73, 8192
    buffer_load_dwordx4 a[12:15], v5, s[56:59], s73 offen offset:3072 sc1
    s_waitcnt lgkmcnt(0)
    s_waitcnt vmcnt(10)
    v_mfma_f32_16x16x32_bf16 a[128:131], v[144:147], a[104:107], a[128:131]
    v_add_f32 v32, v32, v36
    v_add_f32 v33, v33, v37
    v_mfma_f32_16x16x32_bf16 a[132:135], v[148:151], a[104:107], a[132:135]
    v_add_f32 v34, v34, v38
    v_add_f32 v35, v35, v39
    v_mfma_f32_16x16x32_bf16 a[136:139], v[152:155], a[104:107], a[136:139]
    v_add_f32 v40, v40, v44
    v_add_f32 v41, v41, v45
    v_mfma_f32_16x16x32_bf16 a[140:143], v[156:159], a[104:107], a[140:143]
    v_add_f32 v42, v42, v46
    v_add_f32 v43, v43, v47
    s_movk_i32 s73, 12288
    buffer_load_dwordx4 a[16:19], v5, s[56:59], s73 offen offset:3072 sc1
    s_waitcnt vmcnt(10)
    v_mfma_f32_16x16x32_bf16 a[128:131], v[160:163], a[108:111], a[128:131]
    v_lshlrev_b32 v48, 16, v98
    v_and_b32 v49, 0xffff0000, v98
    v_mfma_f32_16x16x32_bf16 a[132:135], v[164:167], a[108:111], a[132:135]
    v_lshlrev_b32 v50, 16, v99
    v_and_b32 v51, 0xffff0000, v99
    v_mfma_f32_16x16x32_bf16 a[136:139], v[168:171], a[108:111], a[136:139]
    v_add_f32 v32, v32, v40
    v_add_f32 v33, v33, v41
    v_mfma_f32_16x16x32_bf16 a[140:143], v[172:175], a[108:111], a[140:143]
    v_add_f32 v34, v34, v42
    v_add_f32 v35, v35, v43
    s_movk_i32 s73, 16384
    buffer_load_dwordx4 a[20:23], v5, s[56:59], s73 offen offset:3072 sc1
    s_waitcnt vmcnt(9)
    v_mfma_f32_16x16x32_bf16 a[128:131], v[176:179], a[112:115], a[128:131]
    v_lshlrev_b32 v52, 16, v106
    v_and_b32 v53, 0xffff0000, v106
    v_mfma_f32_16x16x32_bf16 a[132:135], v[180:183], a[112:115], a[132:135]
    v_lshlrev_b32 v54, 16, v107
    v_and_b32 v55, 0xffff0000, v107
    v_mfma_f32_16x16x32_bf16 a[136:139], v[184:187], a[112:115], a[136:139]
    v_add_f32 v32, v32, v48
    v_add_f32 v33, v33, v49
    v_mfma_f32_16x16x32_bf16 a[140:143], v[188:191], a[112:115], a[140:143]
    v_add_f32 v34, v34, v50
    v_add_f32 v35, v35, v51
    s_movk_i32 s73, 20480
    buffer_load_dwordx4 a[24:27], v5, s[56:59], s73 offen offset:3072 sc1
    s_waitcnt vmcnt(9)
    v_mfma_f32_16x16x32_bf16 a[128:131], v[192:195], a[116:119], a[128:131]
    v_fma_f32 v32, v32, v12, v52
    v_fma_f32 v33, v33, v13, v53
    v_mfma_f32_16x16x32_bf16 a[132:135], v[196:199], a[116:119], a[132:135]
    v_fma_f32 v34, v34, v14, v54
    v_fma_f32 v35, v35, v15, v55
    v_mfma_f32_16x16x32_bf16 a[136:139], v[200:203], a[116:119], a[136:139]
    v_cvt_pk_bf16_f32 v56, v32, v33
    v_cvt_pk_bf16_f32 v57, v34, v35
    v_mfma_f32_16x16x32_bf16 a[140:143], v[204:207], a[116:119], a[140:143]
    s_add_u32 s43, s74, 16384
    buffer_store_dwordx2 v[56:57], v23, s[76:79], s43 offen
    s_movk_i32 s73, 24576
    buffer_load_dwordx4 a[28:31], v5, s[56:59], s73 offen offset:3072 sc1
    s_waitcnt vmcnt(10)
    v_mfma_f32_16x16x32_bf16 a[128:131], v[208:211], a[120:123], a[128:131]
    v_mfma_f32_16x16x32_bf16 a[132:135], v[212:215], a[120:123], a[132:135]
    v_mfma_f32_16x16x32_bf16 a[136:139], v[216:219], a[120:123], a[136:139]
    v_mfma_f32_16x16x32_bf16 a[140:143], v[220:223], a[120:123], a[140:143]
    s_movk_i32 s73, 28672
    buffer_load_dwordx4 a[32:35], v5, s[56:59], s73 offen offset:3072 sc1
    s_waitcnt vmcnt(10)
    v_mfma_f32_16x16x32_bf16 a[128:131], v[224:227], a[124:127], a[128:131]
    v_mfma_f32_16x16x32_bf16 a[132:135], v[228:231], a[124:127], a[132:135]
    v_mfma_f32_16x16x32_bf16 a[136:139], v[232:235], a[124:127], a[136:139]
    v_mfma_f32_16x16x32_bf16 a[140:143], v[236:239], a[124:127], a[140:143]
    s_mov_b32 s73, 32768
    buffer_load_dwordx4 a[36:39], v5, s[56:59], s73 offen offset:3072 sc1
    s_waitcnt vmcnt(10)
    v_mfma_f32_16x16x32_bf16 a[128:131], v[240:243], a[0:3], a[128:131]
    v_mfma_f32_16x16x32_bf16 a[132:135], v[244:247], a[0:3], a[132:135]
    v_mfma_f32_16x16x32_bf16 a[136:139], v[248:251], a[0:3], a[136:139]
    v_mfma_f32_16x16x32_bf16 a[140:143], v[252:255], a[0:3], a[140:143]
    s_mov_b32 s73, 36864
    buffer_load_dwordx4 a[40:43], v5, s[56:59], s73 offen offset:3072 sc1
    s_nop 2
    ds_write_b128 v21, a[128:131] offset:0
    ds_write_b128 v21, a[132:135] offset:1024
    ds_write_b128 v21, a[136:139] offset:2048
    ds_write_b128 v21, a[140:143] offset:3072
    s_waitcnt vmcnt(10)
    v_mfma_f32_16x16x32_bf16 a[144:147], a[192:195], a[4:7], 0
    v_mfma_f32_16x16x32_bf16 a[148:151], a[196:199], a[4:7], 0
    v_mfma_f32_16x16x32_bf16 a[152:155], a[200:203], a[4:7], 0
    v_mfma_f32_16x16x32_bf16 a[156:159], a[204:207], a[4:7], 0
    s_mov_b32 s73, 40960
    buffer_load_dwordx4 a[44:47], v5, s[56:59], s73 offen offset:3072 sc1
    s_waitcnt vmcnt(10)
    v_mfma_f32_16x16x32_bf16 a[144:147], a[208:211], a[8:11], a[144:147]
    v_mfma_f32_16x16x32_bf16 a[148:151], a[212:215], a[8:11], a[148:151]
    v_mfma_f32_16x16x32_bf16 a[152:155], a[216:219], a[8:11], a[152:155]
    v_mfma_f32_16x16x32_bf16 a[156:159], a[220:223], a[8:11], a[156:159]
    s_waitcnt lgkmcnt(0)
    s_barrier
    ds_read_b128 v[32:35], v22 offset:0
    ds_read_b128 v[36:39], v22 offset:4096
    ds_read_b128 v[40:43], v22 offset:8192
    ds_read_b128 v[44:47], v22 offset:12288
    s_waitcnt vmcnt(9)
    v_mfma_f32_16x16x32_bf16 a[144:147], a[224:227], a[12:15], a[144:147]
    v_mfma_f32_16x16x32_bf16 a[148:151], a[228:231], a[12:15], a[148:151]
    v_mfma_f32_16x16x32_bf16 a[152:155], a[232:235], a[12:15], a[152:155]
    v_mfma_f32_16x16x32_bf16 a[156:159], a[236:239], a[12:15], a[156:159]
    s_waitcnt vmcnt(8)
    v_mfma_f32_16x16x32_bf16 a[144:147], a[240:243], a[16:19], a[144:147]
    v_mfma_f32_16x16x32_bf16 a[148:151], a[244:247], a[16:19], a[148:151]
    v_mfma_f32_16x16x32_bf16 a[152:155], a[248:251], a[16:19], a[152:155]
    v_mfma_f32_16x16x32_bf16 a[156:159], a[252:255], a[16:19], a[156:159]
    s_waitcnt lgkmcnt(0)
    s_waitcnt vmcnt(7)
    v_mfma_f32_16x16x32_bf16 a[144:147], v[144:147], a[20:23], a[144:147]
    v_add_f32 v32, v32, v36
    v_add_f32 v33, v33, v37
    v_mfma_f32_16x16x32_bf16 a[148:151], v[148:151], a[20:23], a[148:151]
    v_add_f32 v34, v34, v38
    v_add_f32 v35, v35, v39
    v_mfma_f32_16x16x32_bf16 a[152:155], v[152:155], a[20:23], a[152:155]
    v_add_f32 v40, v40, v44
    v_add_f32 v41, v41, v45
    v_mfma_f32_16x16x32_bf16 a[156:159], v[156:159], a[20:23], a[156:159]
    v_add_f32 v42, v42, v46
    v_add_f32 v43, v43, v47
    s_waitcnt vmcnt(6)
    v_mfma_f32_16x16x32_bf16 a[144:147], v[160:163], a[24:27], a[144:147]
    v_lshlrev_b32 v48, 16, v100
    v_and_b32 v49, 0xffff0000, v100
    v_mfma_f32_16x16x32_bf16 a[148:151], v[164:167], a[24:27], a[148:151]
    v_lshlrev_b32 v50, 16, v101
    v_and_b32 v51, 0xffff0000, v101
    v_mfma_f32_16x16x32_bf16 a[152:155], v[168:171], a[24:27], a[152:155]
    v_add_f32 v32, v32, v40
    v_add_f32 v33, v33, v41
    v_mfma_f32_16x16x32_bf16 a[156:159], v[172:175], a[24:27], a[156:159]
    v_add_f32 v34, v34, v42
    v_add_f32 v35, v35, v43
    s_waitcnt vmcnt(4)
    v_mfma_f32_16x16x32_bf16 a[144:147], v[176:179], a[28:31], a[144:147]
    v_lshlrev_b32 v52, 16, v108
    v_and_b32 v53, 0xffff0000, v108
    v_mfma_f32_16x16x32_bf16 a[148:151], v[180:183], a[28:31], a[148:151]
    v_lshlrev_b32 v54, 16, v109
    v_and_b32 v55, 0xffff0000, v109
    v_mfma_f32_16x16x32_bf16 a[152:155], v[184:187], a[28:31], a[152:155]
    v_add_f32 v32, v32, v48
    v_add_f32 v33, v33, v49
    v_mfma_f32_16x16x32_bf16 a[156:159], v[188:191], a[28:31], a[156:159]
    v_add_f32 v34, v34, v50
    v_add_f32 v35, v35, v51
    s_waitcnt vmcnt(3)
    v_mfma_f32_16x16x32_bf16 a[144:147], v[192:195], a[32:35], a[144:147]
    v_fma_f32 v32, v32, v12, v52
    v_fma_f32 v33, v33, v13, v53
    v_mfma_f32_16x16x32_bf16 a[148:151], v[196:199], a[32:35], a[148:151]
    v_fma_f32 v34, v34, v14, v54
    v_fma_f32 v35, v35, v15, v55
    v_mfma_f32_16x16x32_bf16 a[152:155], v[200:203], a[32:35], a[152:155]
    v_cvt_pk_bf16_f32 v56, v32, v33
    v_cvt_pk_bf16_f32 v57, v34, v35
    v_mfma_f32_16x16x32_bf16 a[156:159], v[204:207], a[32:35], a[156:159]
    s_add_u32 s43, s74, 32768
    buffer_store_dwordx2 v[56:57], v23, s[76:79], s43 offen
    s_waitcnt vmcnt(3)
    v_mfma_f32_16x16x32_bf16 a[144:147], v[208:211], a[36:39], a[144:147]
    v_mfma_f32_16x16x32_bf16 a[148:151], v[212:215], a[36:39], a[148:151]
    v_mfma_f32_16x16x32_bf16 a[152:155], v[216:219], a[36:39], a[152:155]
    v_mfma_f32_16x16x32_bf16 a[156:159], v[220:223], a[36:39], a[156:159]
    s_waitcnt vmcnt(2)
    v_mfma_f32_16x16x32_bf16 a[144:147], v[224:227], a[40:43], a[144:147]
    v_mfma_f32_16x16x32_bf16 a[148:151], v[228:231], a[40:43], a[148:151]
    v_mfma_f32_16x16x32_bf16 a[152:155], v[232:235], a[40:43], a[152:155]
    v_mfma_f32_16x16x32_bf16 a[156:159], v[236:239], a[40:43], a[156:159]
    s_waitcnt vmcnt(1)
    v_mfma_f32_16x16x32_bf16 a[144:147], v[240:243], a[44:47], a[144:147]
    v_mfma_f32_16x16x32_bf16 a[148:151], v[244:247], a[44:47], a[148:151]
    v_mfma_f32_16x16x32_bf16 a[152:155], v[248:251], a[44:47], a[152:155]
    v_mfma_f32_16x16x32_bf16 a[156:159], v[252:255], a[44:47], a[156:159]
    s_nop 4
    ds_write_b128 v21, a[144:147] offset:16384
    ds_write_b128 v21, a[148:151] offset:17408
    ds_write_b128 v21, a[152:155] offset:18432
    ds_write_b128 v21, a[156:159] offset:19456
    s_waitcnt lgkmcnt(0)
    s_barrier
    ds_read_b128 v[32:35], v22 offset:16384
    ds_read_b128 v[36:39], v22 offset:20480
    ds_read_b128 v[40:43], v22 offset:24576
    ds_read_b128 v[44:47], v22 offset:28672
    s_waitcnt lgkmcnt(0)
    v_add_f32 v32, v32, v36
    v_add_f32 v33, v33, v37
    v_add_f32 v34, v34, v38
    v_add_f32 v35, v35, v39
    v_add_f32 v40, v40, v44
    v_add_f32 v41, v41, v45
    v_add_f32 v42, v42, v46
    v_add_f32 v43, v43, v47
    v_lshlrev_b32 v48, 16, v102
    v_and_b32 v49, 0xffff0000, v102
    v_lshlrev_b32 v50, 16, v103
    v_and_b32 v51, 0xffff0000, v103
    v_add_f32 v32, v32, v40
    v_add_f32 v33, v33, v41
    v_add_f32 v34, v34, v42
    v_add_f32 v35, v35, v43
    v_lshlrev_b32 v52, 16, v110
    v_and_b32 v53, 0xffff0000, v110
    v_lshlrev_b32 v54, 16, v111
    v_and_b32 v55, 0xffff0000, v111
    v_add_f32 v32, v32, v48
    v_add_f32 v33, v33, v49
    v_add_f32 v34, v34, v50
    v_add_f32 v35, v35, v51
    v_fma_f32 v32, v32, v12, v52
    v_fma_f32 v33, v33, v13, v53
    v_fma_f32 v34, v34, v14, v54
    v_fma_f32 v35, v35, v15, v55
    v_cvt_pk_bf16_f32 v56, v32, v33
    v_cvt_pk_bf16_f32 v57, v34, v35
    s_add_u32 s43, s74, 49152
    buffer_store_dwordx2 v[56:57], v23, s[76:79], s43 offen
.Lmlp_ke_end_1:
    s_endpgm
CODE_TO:
.section .rodata,"a"
.p2align 6
.amdhsa_kernel adaLN_cond__ssm_conv_s4__mixer_s_mlp__prompt_kernel
  .amdhsa_next_free_vgpr 256
  .amdhsa_next_free_sgpr 82
  .amdhsa_accum_offset 128
  .amdhsa_group_segment_fixed_size 0
  .amdhsa_kernarg_size 152
  .amdhsa_user_sgpr_count 2
  .amdhsa_user_sgpr_kernarg_segment_ptr 1
  .amdhsa_system_sgpr_workgroup_id_x 1
  .amdhsa_float_denorm_mode_32 3
  .amdhsa_float_denorm_mode_16_64 3
  .amdhsa_ieee_mode 0
  .amdhsa_dx10_clamp 0
.end_amdhsa_kernel
.p2align 6
.amdhsa_kernel mlp_kernel
  .amdhsa_next_free_vgpr 512
  .amdhsa_next_free_sgpr 100
  .amdhsa_accum_offset 256
  .amdhsa_group_segment_fixed_size 0
  .amdhsa_kernarg_size 152
  .amdhsa_user_sgpr_count 2
  .amdhsa_user_sgpr_kernarg_segment_ptr 1
  .amdhsa_system_sgpr_workgroup_id_x 1
  .amdhsa_float_denorm_mode_32 3
  .amdhsa_float_denorm_mode_16_64 3
  .amdhsa_ieee_mode 0
  .amdhsa_dx10_clamp 0
.end_amdhsa_kernel
```
